```python
import torch

def _softmax(x, axis=-1):
    return torch.softmax(x, dim=axis)
def _gelu(x):
    return torch.nn.functional.gelu(x, approximate="tanh")
def _silu(x):
    return torch.nn.functional.silu(x)
def _sigmoid(x):
    return torch.sigmoid(x)
def _layernorm(x, axis=-1, eps=1e-5):
    m = x.mean(dim=axis, keepdim=True)
    v = x.var(dim=axis, keepdim=True, unbiased=False)
    return (x - m) / torch.sqrt(v + eps)
def _scatter_add(tgt, idx, src, axis=0):
    return tgt.clone().index_add_(axis, idx, src)
def _segment_sum(src, seg, n):
    out = torch.zeros((n,) + src.shape[1:], dtype=src.dtype)
    return out.index_add_(0, seg, src)
def _pad(x, pw):
    flat = tuple(v for pair in reversed(pw) for v in pair)
    return torch.nn.functional.pad(x, flat)

kernel_name = 'gated_mix__spectral_fnet__dense_activation_relu__prompt'

def setup_inputs():

    _w = (lambda a: (lambda t: t.to(torch.bfloat16) if t.is_floating_point() else t)(torch.as_tensor(a)))
    def _A_setup():
        B, S, D = 1, 2048, 1024
        ns = torch.arange(S)[:, None] * torch.arange(S)[None, :]
        nd = torch.arange(D)[:, None] * torch.arange(D)[None, :]
        Ws_re = torch.cos(-2.0 * torch.pi * ns / S).to(float)
        Ws_im = torch.sin(-2.0 * torch.pi * ns / S).to(float)
        Wd_re = torch.cos(-2.0 * torch.pi * nd / D).to(float)
        Wd_im = torch.sin(-2.0 * torch.pi * nd / D).to(float)
        return {
            "x": _w((lambda *s: torch.randn(*s, dtype=torch.bfloat16) * 0.05)(B, S, D)),
            "dft_seq_re": _w(Ws_re),
            "dft_seq_im": _w(Ws_im),
            "dft_hid_re": _w(Wd_re),
            "dft_hid_im": _w(Wd_im),
        }
    _A_in = _A_setup()

    def _B_setup():
        B, S, D, Dff = 1, 2048, 1024, 3584
        return {
            "x": _w((lambda *s: torch.randn(*s, dtype=torch.bfloat16) * 0.05)(B, S, D)),
            "w1": _w((lambda *s: torch.randn(*s, dtype=torch.bfloat16) * 0.4)(D, Dff)),
            "w2": _w((lambda *s: torch.randn(*s, dtype=torch.bfloat16) * 0.4)(Dff, D)),
        }
    _B_in = _B_setup()

    return {
        "A_x": _A_in["x"],
        "A_dft_seq_re": _A_in["dft_seq_re"],
        "A_dft_seq_im": _A_in["dft_seq_im"],
        "A_dft_hid_re": _A_in["dft_hid_re"],
        "A_dft_hid_im": _A_in["dft_hid_im"],
        "B_x": _B_in["x"],
        "B_w1": _B_in["w1"],
        "B_w2": _B_in["w2"],
        "gate_w": _w((lambda *s: torch.randn(*s, dtype=torch.bfloat16) * 0.05)(1024) * 16.0),
    }

def reference(A_x, A_dft_seq_re, A_dft_seq_im, A_dft_hid_re, A_dft_hid_im, B_x, B_w1, B_w2, gate_w):
    def _A_ref(x, dft_seq_re, dft_seq_im, dft_hid_re, dft_hid_im):
        a = torch.einsum("bsd,ed->bse", x, dft_hid_re)
        b = torch.einsum("bsd,ed->bse", x, dft_hid_im)
        y = torch.einsum("ts,bse->bte", dft_seq_re, a) - torch.einsum("ts,bse->bte", dft_seq_im, b)
        return y

    def _B_ref(x, w1, w2):
        h = torch.einsum("bsd,df->bsf", x, w1)
        zero = torch.zeros_like(h)
        h = torch.maximum(h, zero)
        return torch.einsum("bsf,fd->bsd", h, w2)

    x = A_x
    g = _sigmoid((x * gate_w).sum(-1, keepdims=True))
    a = _A_ref(x, A_dft_seq_re, A_dft_seq_im, A_dft_hid_re, A_dft_hid_im)
    b = _B_ref(x, B_w1, B_w2)
    return g * a + (1 - g) * b
```

```asm
; @launch grid=(256,1,1) block=(512,1,1) lds=153600
.amdgcn_target "amdgcn-amd-amdhsa--gfx950"
.text
.globl gated_mix__spectral_fnet__dense_activation_relu__prompt_kernel
.p2align 8
.type gated_mix__spectral_fnet__dense_activation_relu__prompt_kernel,@function
gated_mix__spectral_fnet__dense_activation_relu__prompt_kernel:
    s_cmp_ge_u32 s2, 256
    s_cbranch_scc1 k_exit
    s_load_dwordx2 s[4:5], s[0:1], 0
    s_load_dwordx4 s[64:67], s[0:1], 48
    s_load_dwordx4 s[8:11], s[0:1], 80
    s_load_dwordx4 s[68:71], s[0:1], 64
    v_lshrrev_b32 v1, 6, v0
    v_and_b32 v240, 63, v0
    s_and_b32 s25, s2, 7
    s_lshr_b32 s26, s2, 3
    v_readfirstlane_b32 s24, v1
    s_and_b32 s27, s25, 1
    s_lshl_b32 s27, s27, 2
    s_and_b32 s28, s26, 3
    s_add_u32 s27, s27, s28
    s_lshr_b32 s28, s25, 1
    s_mul_i32 s28, s28, 7
    s_lshr_b32 s29, s26, 2
    s_add_u32 s28, s28, s29
    s_cmp_ge_u32 s26, 28
    s_cbranch_scc1 k_fft
    s_cmp_lt_u32 s24, 4
    s_cbranch_scc1 g1_compute
    s_cmp_eq_u32 s24, 7
    s_cbranch_scc1 g1_pf
g1_loader:
    s_setprio 3
    s_cmp_eq_u32 s24, 6
    s_cselect_b64 vcc, -1, 0
    v_lshrrev_b32 v241, 3, v240
    v_and_b32 v242, 7, v240
    v_xor_b32 v242, v242, v241
    v_lshlrev_b32 v242, 4, v242
    v_lshl_add_u32 v242, v241, 16, v242
    v_lshrrev_b32 v243, 4, v240
    v_and_b32 v244, 15, v240
    v_lshlrev_b32 v245, 1, v243
    v_xor_b32 v244, v244, v245
    v_lshlrev_b32 v244, 4, v244
    v_mul_u32_u24 v245, 7168, v243
    v_add_u32 v244, v244, v245
    v_cndmask_b32 v242, v242, v244, vcc
    s_sub_u32 s29, s24, 4
    s_lshl_b32 s30, s29, 1
    s_lshl_b32 s31, s27, 2
    s_add_u32 s30, s30, s31
    s_lshl_b32 s30, s30, 11
    s_lshl_b32 s31, s28, 8
    s_cmp_eq_u32 s24, 6
    s_cselect_b32 s30, s31, s30
    v_add_u32 v1, s30, v242
    v_xor_b32 v2, 128, v1
    v_cndmask_b32 v2, v1, v2, vcc
    s_lshl_b32 s39, s29, 14
    s_cmp_eq_u32 s24, 6
    s_mov_b32 s40, 523264
    s_cselect_b32 s40, 27648, s40
    s_add_u32 s41, s40, 4096
    s_cmp_eq_u32 s24, 6
    s_mov_b32 s42, 0xffc81400
    s_cselect_b32 s42, s41, s42
    s_mov_b32 s38, 128
    s_cselect_b32 s38, 458752, s38
    s_mov_b32 s36, 0
    s_waitcnt lgkmcnt(0)
    s_cselect_b32 s60, s64, s4
    s_cselect_b32 s61, s65, s5
    s_mov_b32 s62, 4194304
    s_cselect_b32 s62, 7340032, s62
    s_mov_b32 s63, 0x20000
    s_add_u32 m0, s39, 0
    s_mov_b32 s56, 0
    buffer_load_dwordx4 v1, s[60:63], s56 offen offset:0 lds
    s_add_u32 s56, s56, s40
    buffer_load_dwordx4 v1, s[60:63], s56 offen offset:1024 lds
    s_add_u32 s56, s56, s40
    buffer_load_dwordx4 v2, s[60:63], s56 offen offset:2048 lds
    s_add_u32 s56, s56, s40
    buffer_load_dwordx4 v2, s[60:63], s56 offen offset:3072 lds
    s_add_u32 m0, s39, 4096
    s_add_u32 s56, s56, s41
    buffer_load_dwordx4 v1, s[60:63], s56 offen offset:0 lds
    s_add_u32 s56, s56, s40
    buffer_load_dwordx4 v1, s[60:63], s56 offen offset:1024 lds
    s_add_u32 s56, s56, s40
    buffer_load_dwordx4 v2, s[60:63], s56 offen offset:2048 lds
    s_add_u32 s56, s56, s40
    buffer_load_dwordx4 v2, s[60:63], s56 offen offset:3072 lds
    s_add_u32 m0, s39, 8192
    s_add_u32 s56, s56, s42
    buffer_load_dwordx4 v1, s[60:63], s56 offen offset:0 lds
    s_add_u32 s56, s56, s40
    buffer_load_dwordx4 v1, s[60:63], s56 offen offset:1024 lds
    s_add_u32 s56, s56, s40
    buffer_load_dwordx4 v2, s[60:63], s56 offen offset:2048 lds
    s_add_u32 s56, s56, s40
    buffer_load_dwordx4 v2, s[60:63], s56 offen offset:3072 lds
    s_add_u32 m0, s39, 12288
    s_add_u32 s56, s56, s41
    buffer_load_dwordx4 v1, s[60:63], s56 offen offset:0 lds
    s_add_u32 s56, s56, s40
    buffer_load_dwordx4 v1, s[60:63], s56 offen offset:1024 lds
    s_add_u32 s56, s56, s40
    buffer_load_dwordx4 v2, s[60:63], s56 offen offset:2048 lds
    s_add_u32 s56, s56, s40
    buffer_load_dwordx4 v2, s[60:63], s56 offen offset:3072 lds
    s_add_u32 s36, s36, s38
    s_add_u32 s37, s39, 49152
    s_add_u32 m0, s37, 0
    s_mov_b32 s56, s36
    buffer_load_dwordx4 v1, s[60:63], s56 offen offset:0 lds
    s_add_u32 s56, s56, s40
    buffer_load_dwordx4 v1, s[60:63], s56 offen offset:1024 lds
    s_add_u32 s56, s56, s40
    buffer_load_dwordx4 v2, s[60:63], s56 offen offset:2048 lds
    s_add_u32 s56, s56, s40
    buffer_load_dwordx4 v2, s[60:63], s56 offen offset:3072 lds
    s_add_u32 m0, s37, 4096
    s_add_u32 s56, s56, s41
    buffer_load_dwordx4 v1, s[60:63], s56 offen offset:0 lds
    s_add_u32 s56, s56, s40
    buffer_load_dwordx4 v1, s[60:63], s56 offen offset:1024 lds
    s_add_u32 s56, s56, s40
    buffer_load_dwordx4 v2, s[60:63], s56 offen offset:2048 lds
    s_add_u32 s56, s56, s40
    buffer_load_dwordx4 v2, s[60:63], s56 offen offset:3072 lds
    s_add_u32 s56, s56, s42
    s_add_u32 s35, s39, 147456
    s_mov_b32 s33, 2
    s_setprio 0
    s_waitcnt vmcnt(8)
    s_barrier
    s_add_u32 m0, s37, 8192
    s_nop 0
    buffer_load_dwordx4 v1, s[60:63], s56 offen offset:0 lds
    s_add_u32 s56, s56, s40
    buffer_load_dwordx4 v1, s[60:63], s56 offen offset:1024 lds
    s_add_u32 s56, s56, s40
    buffer_load_dwordx4 v2, s[60:63], s56 offen offset:2048 lds
    s_add_u32 s56, s56, s40
    buffer_load_dwordx4 v2, s[60:63], s56 offen offset:3072 lds
    s_add_u32 m0, s37, 12288
    s_add_u32 s56, s56, s41
    buffer_load_dwordx4 v1, s[60:63], s56 offen offset:0 lds
    s_add_u32 s56, s56, s40
    buffer_load_dwordx4 v1, s[60:63], s56 offen offset:1024 lds
    s_add_u32 s56, s56, s40
    buffer_load_dwordx4 v2, s[60:63], s56 offen offset:2048 lds
    s_add_u32 s56, s56, s40
    buffer_load_dwordx4 v2, s[60:63], s56 offen offset:3072 lds
g1_ldloop:
    s_add_u32 s36, s36, s38
    s_add_u32 s37, s37, 49152
    s_cmp_eq_u32 s37, s35
    s_cselect_b32 s37, s39, s37
    s_add_u32 m0, s37, 0
    s_mov_b32 s56, s36
    buffer_load_dwordx4 v1, s[60:63], s56 offen offset:0 lds
    s_add_u32 s56, s56, s40
    buffer_load_dwordx4 v1, s[60:63], s56 offen offset:1024 lds
    s_add_u32 s56, s56, s40
    buffer_load_dwordx4 v2, s[60:63], s56 offen offset:2048 lds
    s_add_u32 s56, s56, s40
    buffer_load_dwordx4 v2, s[60:63], s56 offen offset:3072 lds
    s_add_u32 m0, s37, 4096
    s_add_u32 s56, s56, s41
    buffer_load_dwordx4 v1, s[60:63], s56 offen offset:0 lds
    s_add_u32 s56, s56, s40
    buffer_load_dwordx4 v1, s[60:63], s56 offen offset:1024 lds
    s_add_u32 s56, s56, s40
    buffer_load_dwordx4 v2, s[60:63], s56 offen offset:2048 lds
    s_add_u32 s56, s56, s40
    buffer_load_dwordx4 v2, s[60:63], s56 offen offset:3072 lds
    s_add_u32 m0, s37, 8192
    s_add_u32 s56, s56, s42
    buffer_load_dwordx4 v1, s[60:63], s56 offen offset:0 lds
    s_add_u32 s56, s56, s40
    buffer_load_dwordx4 v1, s[60:63], s56 offen offset:1024 lds
    s_add_u32 s56, s56, s40
    buffer_load_dwordx4 v2, s[60:63], s56 offen offset:2048 lds
    s_add_u32 s56, s56, s40
    buffer_load_dwordx4 v2, s[60:63], s56 offen offset:3072 lds
    s_add_u32 m0, s37, 12288
    s_add_u32 s56, s56, s41
    buffer_load_dwordx4 v1, s[60:63], s56 offen offset:0 lds
    s_add_u32 s56, s56, s40
    buffer_load_dwordx4 v1, s[60:63], s56 offen offset:1024 lds
    s_add_u32 s56, s56, s40
    buffer_load_dwordx4 v2, s[60:63], s56 offen offset:2048 lds
    s_add_u32 s56, s56, s40
    buffer_load_dwordx4 v2, s[60:63], s56 offen offset:3072 lds
    s_add_u32 s33, s33, 1
    s_waitcnt vmcnt(16)
    s_barrier
    s_cmp_lt_u32 s33, 16
    s_cbranch_scc1 g1_ldloop
    s_waitcnt vmcnt(0)
    s_barrier
    s_barrier
    s_barrier
    s_branch pb_load
g1_pf:
    s_waitcnt lgkmcnt(0)
    s_mov_b32 s12, s4
    s_mov_b32 s13, s5
    s_mov_b32 s14, 4194304
    s_mov_b32 s15, 0x20000
    s_mov_b32 s16, s64
    s_mov_b32 s17, s65
    s_mov_b32 s18, 7340032
    s_mov_b32 s19, 0x20000
    s_cmp_lg_u32 s2, 0
    s_cbranch_scc1 g1_nononce
    s_mov_b32 s88, s8
    s_mov_b32 s89, s9
    s_mov_b32 s90, 256
    s_mov_b32 s91, 0x20000
    s_memrealtime s[30:31]
    s_waitcnt lgkmcnt(0)
    s_or_b32 s30, s30, 1
    v_mov_b32 v241, s30
    v_mov_b32 v242, 0
    buffer_store_dword v241, v242, s[88:91], 0 offen sc1
g1_nononce:
    s_cmp_ge_u32 s26, 2
    s_cbranch_scc1 g1_nocpf
    s_getpc_b64 s[48:49]
cpf_232:
    s_add_u32 s48, s48, gated_mix__spectral_fnet__dense_activation_relu__prompt_kernel-cpf_232
    s_addc_u32 s49, s49, -1
    s_mov_b32 s50, k_exit-gated_mix__spectral_fnet__dense_activation_relu__prompt_kernel-4
    v_lshlrev_b32 v14, 7, v240
    v_min_u32 v14, s50, v14
    v_and_b32 v14, -4, v14
    global_load_dword v15, v14, s[48:49]
    v_lshlrev_b32 v14, 7, v240
    v_add_u32 v14, 8192, v14
    v_min_u32 v14, s50, v14
    v_and_b32 v14, -4, v14
    global_load_dword v15, v14, s[48:49]
    v_lshlrev_b32 v14, 7, v240
    v_add_u32 v14, 16384, v14
    v_min_u32 v14, s50, v14
    v_and_b32 v14, -4, v14
    global_load_dword v15, v14, s[48:49]
g1_nocpf:
    s_barrier
    v_mov_b32 v244, 0x7f000000
    s_mul_i32 s29, s2, 10
    v_add_u32 v241, s29, v240
    v_lshlrev_b32 v1, 11, v241
    v_cmp_gt_u32 vcc, 10, v240
    s_nop 1
    v_cndmask_b32 v1, v244, v1, vcc
    v_cmp_gt_u32 vcc, 2048, v241
    s_nop 1
    v_cndmask_b32 v1, v244, v1, vcc
    s_lshl_b32 s29, s2, 4
    v_add_u32 v242, s29, v240
    v_mul_u32_u24 v243, 1171, v242
    v_lshrrev_b32 v243, 16, v243
    v_mul_u32_u24 v245, 56, v243
    v_sub_u32 v245, v242, v245
    v_mul_u32_u24 v243, 7168, v243
    v_lshl_add_u32 v2, v245, 7, v243
    v_cmp_gt_u32 vcc, 16, v240
    s_nop 1
    v_cndmask_b32 v2, v244, v2, vcc
    s_lshl_b32 s30, s2, 15
    v_lshlrev_b32 v3, 7, v240
    v_add_u32 v3, s30, v3
    v_cmp_gt_u32 vcc, 43, v240
    s_nop 1
    v_cndmask_b32 v3, v244, v3, vcc
    s_mul_i32 s30, s2, 128
    s_add_u32 s30, s30, 0
    v_add_u32 v241, s30, v240
    v_lshlrev_b32 v3, 7, v241
    v_add_u32 v242, 1835008, v3
    v_cmp_le_u32 vcc, 14336, v241
    s_nop 1
    v_cndmask_b32 v3, v3, v242, vcc
    v_cmp_gt_u32 vcc, 64, v240
    s_nop 1
    v_cndmask_b32 v3, v244, v3, vcc
    v_cmp_gt_u32 vcc, 28672, v241
    s_nop 1
    v_cndmask_b32 v3, v244, v3, vcc
    s_mul_i32 s30, s2, 128
    s_add_u32 s30, s30, 64
    v_add_u32 v241, s30, v240
    v_lshlrev_b32 v4, 7, v241
    v_add_u32 v242, 1835008, v4
    v_cmp_le_u32 vcc, 14336, v241
    s_nop 1
    v_cndmask_b32 v4, v4, v242, vcc
    v_cmp_gt_u32 vcc, 64, v240
    s_nop 1
    v_cndmask_b32 v4, v244, v4, vcc
    v_cmp_gt_u32 vcc, 28672, v241
    s_nop 1
    v_cndmask_b32 v4, v244, v4, vcc
    s_mov_b32 s72, s66
    s_mov_b32 s73, s67
    s_mov_b32 s74, 7340032
    s_mov_b32 s75, 0x20000
    s_mov_b32 s36, 256
    s_mov_b32 s37, 917504
    s_mov_b32 s38, 0
    buffer_load_dword v10, v1, s[12:15], s36 offen
    buffer_load_dword v11, v2, s[16:19], s37 offen
    s_add_u32 s36, s36, 128
    s_add_u32 s37, s37, 458752
    buffer_load_dword v10, v1, s[12:15], s36 offen
    buffer_load_dword v11, v2, s[16:19], s37 offen
    s_add_u32 s36, s36, 128
    s_add_u32 s37, s37, 458752
    buffer_load_dword v10, v1, s[12:15], s36 offen
    buffer_load_dword v11, v2, s[16:19], s37 offen
    s_add_u32 s36, s36, 128
    s_add_u32 s37, s37, 458752
    s_mov_b32 s33, 0
g1_pfloop:
    s_cmp_ge_u32 s36, 2048
    s_cbranch_scc1 g1_pfw2
    buffer_load_dword v10, v1, s[12:15], s36 offen
    buffer_load_dword v11, v2, s[16:19], s37 offen
    s_add_u32 s36, s36, 128
    s_add_u32 s37, s37, 458752
g1_pfw2:
    s_cmp_lg_u32 s33, 13
    s_cbranch_scc1 g1_pfh0
    buffer_load_dword v12, v3, s[72:75], 0 offen
g1_pfh0:
    s_cmp_lg_u32 s33, 14
    s_cbranch_scc1 g1_pfh1
    buffer_load_dword v12, v4, s[72:75], 0 offen
g1_pfh1:
    s_branch g1_pfbar
    s_cmp_lt_u32 s33, 10
    s_cbranch_scc1 g1_pfbar
    s_cmp_ge_u32 s38, 32768
    s_cbranch_scc1 g1_pfbar
    buffer_load_dword v12, v3, s[72:75], s38 offen
    s_add_u32 s38, s38, 5504
g1_pfbar:
    s_cmp_lg_u32 s33, 10
    s_cbranch_scc1 g1_nocpf2
    s_cmp_ge_u32 s26, 4
    s_cbranch_scc1 g1_nocpf2
    s_getpc_b64 s[48:49]
cpf_356:
    s_add_u32 s48, s48, g1_loop-cpf_356
    s_addc_u32 s49, s49, 0
    s_mov_b32 s50, k_fft-g1_loop-4
    v_lshlrev_b32 v14, 7, v240
    v_min_u32 v14, s50, v14
    v_and_b32 v14, -4, v14
    global_load_dword v15, v14, s[48:49]
    v_lshlrev_b32 v14, 7, v240
    v_add_u32 v14, 8192, v14
    v_min_u32 v14, s50, v14
    v_and_b32 v14, -4, v14
    global_load_dword v15, v14, s[48:49]
g1_nocpf2:
    s_barrier
    s_add_u32 s33, s33, 1
    s_cmp_lt_u32 s33, 16
    s_cbranch_scc1 g1_pfloop
    s_barrier
    s_branch pb_load
g1_compute:
    s_mul_i32 s29, s27, 28
    s_add_u32 s29, s29, s28
    s_lshl_b32 s29, s29, 2
    s_add_u32 s29, s29, s24
    s_lshl_b32 s29, s29, 7
    s_add_u32 s96, s29, 16384
    s_and_b32 s29, s24, 1
    s_lshr_b32 s30, s24, 1
    v_and_b32 v241, 15, v240
    v_lshrrev_b32 v242, 4, v240
    v_and_b32 v243, 7, v241
    v_xor_b32 v243, v243, v242
    v_lshlrev_b32 v243, 4, v243
    v_lshl_add_u32 v243, v241, 7, v243
    s_lshl_b32 s31, s29, 14
    v_add_u32 v224, s31, v243
    v_xor_b32 v225, 64, v224
    v_bfe_u32 v243, v240, 2, 2
    v_and_b32 v244, 3, v240
    v_and_b32 v245, 1, v242
    v_lshl_add_u32 v245, v245, 2, v243
    v_lshl_add_u32 v246, v242, 3, v243
    v_lshlrev_b32 v246, 8, v246
    v_and_b32 v247, 1, v244
    v_lshl_add_u32 v246, v247, 3, v246
    v_add_u32 v246, 32768, v246
    v_lshrrev_b32 v247, 1, v244
    s_lshl_b32 s31, s30, 3
    v_add_u32 v247, s31, v247
    v_lshlrev_b32 v245, 1, v245
    v_xor_b32 v247, v247, v245
    v_xor_b32 v248, 0, v247
    v_lshl_add_u32 v226, v248, 4, v246
    v_xor_b32 v248, 2, v247
    v_lshl_add_u32 v227, v248, 4, v246
    v_xor_b32 v248, 4, v247
    v_lshl_add_u32 v228, v248, 4, v246
    v_xor_b32 v248, 6, v247
    v_lshl_add_u32 v229, v248, 4, v246
    v_mov_b32 v0, 0
    v_mov_b32 v1, 0
    v_mov_b32 v2, 0
    v_mov_b32 v3, 0
    v_mov_b32 v4, 0
    v_mov_b32 v5, 0
    v_mov_b32 v6, 0
    v_mov_b32 v7, 0
    v_mov_b32 v8, 0
    v_mov_b32 v9, 0
    v_mov_b32 v10, 0
    v_mov_b32 v11, 0
    v_mov_b32 v12, 0
    v_mov_b32 v13, 0
    v_mov_b32 v14, 0
    v_mov_b32 v15, 0
    v_mov_b32 v16, 0
    v_mov_b32 v17, 0
    v_mov_b32 v18, 0
    v_mov_b32 v19, 0
    v_mov_b32 v20, 0
    v_mov_b32 v21, 0
    v_mov_b32 v22, 0
    v_mov_b32 v23, 0
    v_mov_b32 v24, 0
    v_mov_b32 v25, 0
    v_mov_b32 v26, 0
    v_mov_b32 v27, 0
    v_mov_b32 v28, 0
    v_mov_b32 v29, 0
    v_mov_b32 v30, 0
    v_mov_b32 v31, 0
    v_mov_b32 v32, 0
    v_mov_b32 v33, 0
    v_mov_b32 v34, 0
    v_mov_b32 v35, 0
    v_mov_b32 v36, 0
    v_mov_b32 v37, 0
    v_mov_b32 v38, 0
    v_mov_b32 v39, 0
    v_mov_b32 v40, 0
    v_mov_b32 v41, 0
    v_mov_b32 v42, 0
    v_mov_b32 v43, 0
    v_mov_b32 v44, 0
    v_mov_b32 v45, 0
    v_mov_b32 v46, 0
    v_mov_b32 v47, 0
    v_mov_b32 v48, 0
    v_mov_b32 v49, 0
    v_mov_b32 v50, 0
    v_mov_b32 v51, 0
    v_mov_b32 v52, 0
    v_mov_b32 v53, 0
    v_mov_b32 v54, 0
    v_mov_b32 v55, 0
    v_mov_b32 v56, 0
    v_mov_b32 v57, 0
    v_mov_b32 v58, 0
    v_mov_b32 v59, 0
    v_mov_b32 v60, 0
    v_mov_b32 v61, 0
    v_mov_b32 v62, 0
    v_mov_b32 v63, 0
    v_mov_b32 v64, 0
    v_mov_b32 v65, 0
    v_mov_b32 v66, 0
    v_mov_b32 v67, 0
    v_mov_b32 v68, 0
    v_mov_b32 v69, 0
    v_mov_b32 v70, 0
    v_mov_b32 v71, 0
    v_mov_b32 v72, 0
    v_mov_b32 v73, 0
    v_mov_b32 v74, 0
    v_mov_b32 v75, 0
    v_mov_b32 v76, 0
    v_mov_b32 v77, 0
    v_mov_b32 v78, 0
    v_mov_b32 v79, 0
    v_mov_b32 v80, 0
    v_mov_b32 v81, 0
    v_mov_b32 v82, 0
    v_mov_b32 v83, 0
    v_mov_b32 v84, 0
    v_mov_b32 v85, 0
    v_mov_b32 v86, 0
    v_mov_b32 v87, 0
    v_mov_b32 v88, 0
    v_mov_b32 v89, 0
    v_mov_b32 v90, 0
    v_mov_b32 v91, 0
    v_mov_b32 v92, 0
    v_mov_b32 v93, 0
    v_mov_b32 v94, 0
    v_mov_b32 v95, 0
    v_mov_b32 v96, 0
    v_mov_b32 v97, 0
    v_mov_b32 v98, 0
    v_mov_b32 v99, 0
    v_mov_b32 v100, 0
    v_mov_b32 v101, 0
    v_mov_b32 v102, 0
    v_mov_b32 v103, 0
    v_mov_b32 v104, 0
    v_mov_b32 v105, 0
    v_mov_b32 v106, 0
    v_mov_b32 v107, 0
    v_mov_b32 v108, 0
    v_mov_b32 v109, 0
    v_mov_b32 v110, 0
    v_mov_b32 v111, 0
    v_mov_b32 v112, 0
    v_mov_b32 v113, 0
    v_mov_b32 v114, 0
    v_mov_b32 v115, 0
    v_mov_b32 v116, 0
    v_mov_b32 v117, 0
    v_mov_b32 v118, 0
    v_mov_b32 v119, 0
    v_mov_b32 v120, 0
    v_mov_b32 v121, 0
    v_mov_b32 v122, 0
    v_mov_b32 v123, 0
    v_mov_b32 v124, 0
    v_mov_b32 v125, 0
    v_mov_b32 v126, 0
    v_mov_b32 v127, 0
    s_waitcnt lgkmcnt(0)
    s_mov_b32 s20, s10
    s_mov_b32 s21, s11
    s_mov_b32 s22, 14680064
    s_mov_b32 s23, 0x20000
    s_mov_b32 s88, s8
    s_mov_b32 s89, s9
    s_mov_b32 s90, 256
    s_mov_b32 s91, 0x20000
    s_mov_b32 s32, 0
    s_mov_b32 s33, 15
    s_mov_b32 s36, 49152
    s_mov_b32 s37, 0xfffe8000
    s_barrier
    ds_read_b64_tr_b16 v[160:161], v226 offset:0
    ds_read_b64_tr_b16 v[162:163], v226 offset:1024
    ds_read_b128 v[128:131], v224 offset:0
    ds_read_b64_tr_b16 v[164:165], v227 offset:0
    ds_read_b64_tr_b16 v[166:167], v227 offset:1024
    ds_read_b64_tr_b16 v[168:169], v228 offset:0
    ds_read_b64_tr_b16 v[170:171], v228 offset:1024
    ds_read_b64_tr_b16 v[172:173], v229 offset:0
    ds_read_b64_tr_b16 v[174:175], v229 offset:1024
    ds_read_b128 v[132:135], v224 offset:2048
    ds_read_b128 v[136:139], v224 offset:4096
    ds_read_b128 v[140:143], v224 offset:6144
    ds_read_b128 v[144:147], v224 offset:8192
    ds_read_b128 v[148:151], v224 offset:10240
    ds_read_b128 v[152:155], v224 offset:12288
    ds_read_b128 v[156:159], v224 offset:14336
    s_waitcnt lgkmcnt(0)
g1_loop:
    v_mfma_f32_16x16x32_bf16 v[0:3], v[160:163], v[128:131], v[0:3]
    ds_read_b64_tr_b16 v[208:209], v226 offset:8192
    v_mfma_f32_16x16x32_bf16 v[4:7], v[164:167], v[128:131], v[4:7]
    ds_read_b64_tr_b16 v[210:211], v226 offset:9216
    v_mfma_f32_16x16x32_bf16 v[8:11], v[168:171], v[128:131], v[8:11]
    ds_read_b128 v[176:179], v225 offset:0
    v_mfma_f32_16x16x32_bf16 v[12:15], v[172:175], v[128:131], v[12:15]
    ds_read_b64_tr_b16 v[212:213], v227 offset:8192
    v_mfma_f32_16x16x32_bf16 v[16:19], v[160:163], v[132:135], v[16:19]
    ds_read_b64_tr_b16 v[214:215], v227 offset:9216
    v_mfma_f32_16x16x32_bf16 v[20:23], v[164:167], v[132:135], v[20:23]
    ds_read_b64_tr_b16 v[216:217], v228 offset:8192
    v_mfma_f32_16x16x32_bf16 v[24:27], v[168:171], v[132:135], v[24:27]
    ds_read_b64_tr_b16 v[218:219], v228 offset:9216
    v_mfma_f32_16x16x32_bf16 v[28:31], v[172:175], v[132:135], v[28:31]
    ds_read_b64_tr_b16 v[220:221], v229 offset:8192
    v_mfma_f32_16x16x32_bf16 v[32:35], v[160:163], v[136:139], v[32:35]
    ds_read_b64_tr_b16 v[222:223], v229 offset:9216
    v_mfma_f32_16x16x32_bf16 v[36:39], v[164:167], v[136:139], v[36:39]
    ds_read_b128 v[180:183], v225 offset:2048
    v_mfma_f32_16x16x32_bf16 v[40:43], v[168:171], v[136:139], v[40:43]
    ds_read_b128 v[184:187], v225 offset:4096
    v_mfma_f32_16x16x32_bf16 v[44:47], v[172:175], v[136:139], v[44:47]
    ds_read_b128 v[188:191], v225 offset:6144
    v_mfma_f32_16x16x32_bf16 v[48:51], v[160:163], v[140:143], v[48:51]
    ds_read_b128 v[192:195], v225 offset:8192
    v_mfma_f32_16x16x32_bf16 v[52:55], v[164:167], v[140:143], v[52:55]
    ds_read_b128 v[196:199], v225 offset:10240
    v_mfma_f32_16x16x32_bf16 v[56:59], v[168:171], v[140:143], v[56:59]
    ds_read_b128 v[200:203], v225 offset:12288
    v_mfma_f32_16x16x32_bf16 v[60:63], v[172:175], v[140:143], v[60:63]
    ds_read_b128 v[204:207], v225 offset:14336
    v_mfma_f32_16x16x32_bf16 v[64:67], v[160:163], v[144:147], v[64:67]
    s_add_u32 s32, s32, 1
    v_mfma_f32_16x16x32_bf16 v[68:71], v[164:167], v[144:147], v[68:71]
    s_cmp_eq_u32 s32, 3
    v_mfma_f32_16x16x32_bf16 v[72:75], v[168:171], v[144:147], v[72:75]
    s_cselect_b32 s35, s37, s36
    v_mfma_f32_16x16x32_bf16 v[76:79], v[172:175], v[144:147], v[76:79]
    s_cselect_b32 s32, 0, s32
    v_mfma_f32_16x16x32_bf16 v[80:83], v[160:163], v[148:151], v[80:83]
    v_add_u32 v224, s35, v224
    v_mfma_f32_16x16x32_bf16 v[84:87], v[164:167], v[148:151], v[84:87]
    v_add_u32 v225, s35, v225
    v_mfma_f32_16x16x32_bf16 v[88:91], v[168:171], v[148:151], v[88:91]
    v_add_u32 v226, s35, v226
    v_mfma_f32_16x16x32_bf16 v[92:95], v[172:175], v[148:151], v[92:95]
    v_add_u32 v227, s35, v227
    v_mfma_f32_16x16x32_bf16 v[96:99], v[160:163], v[152:155], v[96:99]
    v_add_u32 v228, s35, v228
    v_mfma_f32_16x16x32_bf16 v[100:103], v[164:167], v[152:155], v[100:103]
    v_add_u32 v229, s35, v229
    v_mfma_f32_16x16x32_bf16 v[104:107], v[168:171], v[152:155], v[104:107]
    v_mfma_f32_16x16x32_bf16 v[108:111], v[172:175], v[152:155], v[108:111]
    v_mfma_f32_16x16x32_bf16 v[112:115], v[160:163], v[156:159], v[112:115]
    v_mfma_f32_16x16x32_bf16 v[116:119], v[164:167], v[156:159], v[116:119]
    v_mfma_f32_16x16x32_bf16 v[120:123], v[168:171], v[156:159], v[120:123]
    v_mfma_f32_16x16x32_bf16 v[124:127], v[172:175], v[156:159], v[124:127]
    s_waitcnt lgkmcnt(0)
    s_barrier
    v_mfma_f32_16x16x32_bf16 v[0:3], v[208:211], v[176:179], v[0:3]
    ds_read_b64_tr_b16 v[160:161], v226 offset:0
    v_mfma_f32_16x16x32_bf16 v[4:7], v[212:215], v[176:179], v[4:7]
    ds_read_b64_tr_b16 v[162:163], v226 offset:1024
    v_mfma_f32_16x16x32_bf16 v[8:11], v[216:219], v[176:179], v[8:11]
    ds_read_b128 v[128:131], v224 offset:0
    v_mfma_f32_16x16x32_bf16 v[12:15], v[220:223], v[176:179], v[12:15]
    ds_read_b64_tr_b16 v[164:165], v227 offset:0
    v_mfma_f32_16x16x32_bf16 v[16:19], v[208:211], v[180:183], v[16:19]
    ds_read_b64_tr_b16 v[166:167], v227 offset:1024
    v_mfma_f32_16x16x32_bf16 v[20:23], v[212:215], v[180:183], v[20:23]
    ds_read_b64_tr_b16 v[168:169], v228 offset:0
    v_mfma_f32_16x16x32_bf16 v[24:27], v[216:219], v[180:183], v[24:27]
    ds_read_b64_tr_b16 v[170:171], v228 offset:1024
    v_mfma_f32_16x16x32_bf16 v[28:31], v[220:223], v[180:183], v[28:31]
    ds_read_b64_tr_b16 v[172:173], v229 offset:0
    v_mfma_f32_16x16x32_bf16 v[32:35], v[208:211], v[184:187], v[32:35]
    ds_read_b64_tr_b16 v[174:175], v229 offset:1024
    v_mfma_f32_16x16x32_bf16 v[36:39], v[212:215], v[184:187], v[36:39]
    ds_read_b128 v[132:135], v224 offset:2048
    v_mfma_f32_16x16x32_bf16 v[40:43], v[216:219], v[184:187], v[40:43]
    ds_read_b128 v[136:139], v224 offset:4096
    v_mfma_f32_16x16x32_bf16 v[44:47], v[220:223], v[184:187], v[44:47]
    ds_read_b128 v[140:143], v224 offset:6144
    v_mfma_f32_16x16x32_bf16 v[48:51], v[208:211], v[188:191], v[48:51]
    ds_read_b128 v[144:147], v224 offset:8192
    v_mfma_f32_16x16x32_bf16 v[52:55], v[212:215], v[188:191], v[52:55]
    ds_read_b128 v[148:151], v224 offset:10240
    v_mfma_f32_16x16x32_bf16 v[56:59], v[216:219], v[188:191], v[56:59]
    ds_read_b128 v[152:155], v224 offset:12288
    v_mfma_f32_16x16x32_bf16 v[60:63], v[220:223], v[188:191], v[60:63]
    ds_read_b128 v[156:159], v224 offset:14336
    v_mfma_f32_16x16x32_bf16 v[64:67], v[208:211], v[192:195], v[64:67]
    s_sub_u32 s33, s33, 1
    v_mfma_f32_16x16x32_bf16 v[68:71], v[212:215], v[192:195], v[68:71]
    v_mfma_f32_16x16x32_bf16 v[72:75], v[216:219], v[192:195], v[72:75]
    v_mfma_f32_16x16x32_bf16 v[76:79], v[220:223], v[192:195], v[76:79]
    v_mfma_f32_16x16x32_bf16 v[80:83], v[208:211], v[196:199], v[80:83]
    v_mfma_f32_16x16x32_bf16 v[84:87], v[212:215], v[196:199], v[84:87]
    v_mfma_f32_16x16x32_bf16 v[88:91], v[216:219], v[196:199], v[88:91]
    v_mfma_f32_16x16x32_bf16 v[92:95], v[220:223], v[196:199], v[92:95]
    v_mfma_f32_16x16x32_bf16 v[96:99], v[208:211], v[200:203], v[96:99]
    v_mfma_f32_16x16x32_bf16 v[100:103], v[212:215], v[200:203], v[100:103]
    v_mfma_f32_16x16x32_bf16 v[104:107], v[216:219], v[200:203], v[104:107]
    v_mfma_f32_16x16x32_bf16 v[108:111], v[220:223], v[200:203], v[108:111]
    v_mfma_f32_16x16x32_bf16 v[112:115], v[208:211], v[204:207], v[112:115]
    v_mfma_f32_16x16x32_bf16 v[116:119], v[212:215], v[204:207], v[116:119]
    v_mfma_f32_16x16x32_bf16 v[120:123], v[216:219], v[204:207], v[120:123]
    v_mfma_f32_16x16x32_bf16 v[124:127], v[220:223], v[204:207], v[124:127]
    s_cmp_lg_u32 s33, 0
    s_waitcnt lgkmcnt(0)
    s_cbranch_scc1 g1_loop
    v_mfma_f32_16x16x32_bf16 v[0:3], v[160:163], v[128:131], v[0:3]
    ds_read_b64_tr_b16 v[208:209], v226 offset:8192
    v_mfma_f32_16x16x32_bf16 v[4:7], v[164:167], v[128:131], v[4:7]
    ds_read_b64_tr_b16 v[210:211], v226 offset:9216
    v_mfma_f32_16x16x32_bf16 v[8:11], v[168:171], v[128:131], v[8:11]
    ds_read_b128 v[176:179], v225 offset:0
    v_mfma_f32_16x16x32_bf16 v[12:15], v[172:175], v[128:131], v[12:15]
    ds_read_b64_tr_b16 v[212:213], v227 offset:8192
    v_mfma_f32_16x16x32_bf16 v[16:19], v[160:163], v[132:135], v[16:19]
    ds_read_b64_tr_b16 v[214:215], v227 offset:9216
    v_mfma_f32_16x16x32_bf16 v[20:23], v[164:167], v[132:135], v[20:23]
    ds_read_b64_tr_b16 v[216:217], v228 offset:8192
    v_mfma_f32_16x16x32_bf16 v[24:27], v[168:171], v[132:135], v[24:27]
    ds_read_b64_tr_b16 v[218:219], v228 offset:9216
    v_mfma_f32_16x16x32_bf16 v[28:31], v[172:175], v[132:135], v[28:31]
    ds_read_b64_tr_b16 v[220:221], v229 offset:8192
    v_mfma_f32_16x16x32_bf16 v[32:35], v[160:163], v[136:139], v[32:35]
    ds_read_b64_tr_b16 v[222:223], v229 offset:9216
    v_mfma_f32_16x16x32_bf16 v[36:39], v[164:167], v[136:139], v[36:39]
    ds_read_b128 v[180:183], v225 offset:2048
    v_mfma_f32_16x16x32_bf16 v[40:43], v[168:171], v[136:139], v[40:43]
    ds_read_b128 v[184:187], v225 offset:4096
    v_mfma_f32_16x16x32_bf16 v[44:47], v[172:175], v[136:139], v[44:47]
    ds_read_b128 v[188:191], v225 offset:6144
    v_mfma_f32_16x16x32_bf16 v[48:51], v[160:163], v[140:143], v[48:51]
    ds_read_b128 v[192:195], v225 offset:8192
    v_mfma_f32_16x16x32_bf16 v[52:55], v[164:167], v[140:143], v[52:55]
    ds_read_b128 v[196:199], v225 offset:10240
    v_mfma_f32_16x16x32_bf16 v[56:59], v[168:171], v[140:143], v[56:59]
    ds_read_b128 v[200:203], v225 offset:12288
    v_mfma_f32_16x16x32_bf16 v[60:63], v[172:175], v[140:143], v[60:63]
    ds_read_b128 v[204:207], v225 offset:14336
    v_mfma_f32_16x16x32_bf16 v[64:67], v[160:163], v[144:147], v[64:67]
    s_lshl_b32 s34, s27, 4
    v_mfma_f32_16x16x32_bf16 v[68:71], v[164:167], v[144:147], v[68:71]
    s_lshl_b32 s35, s29, 3
    v_mfma_f32_16x16x32_bf16 v[72:75], v[168:171], v[144:147], v[72:75]
    s_add_u32 s34, s34, s35
    v_mfma_f32_16x16x32_bf16 v[76:79], v[172:175], v[144:147], v[76:79]
    s_mul_i32 s34, s34, 112
    v_mfma_f32_16x16x32_bf16 v[80:83], v[160:163], v[148:151], v[80:83]
    s_lshl_b32 s35, s28, 2
    v_mfma_f32_16x16x32_bf16 v[84:87], v[164:167], v[148:151], v[84:87]
    s_add_u32 s34, s34, s35
    v_mfma_f32_16x16x32_bf16 v[88:91], v[168:171], v[148:151], v[88:91]
    s_lshl_b32 s35, s30, 1
    v_mfma_f32_16x16x32_bf16 v[92:95], v[172:175], v[148:151], v[92:95]
    s_add_u32 s34, s34, s35
    v_mfma_f32_16x16x32_bf16 v[96:99], v[160:163], v[152:155], v[96:99]
    s_lshl_b32 s34, s34, 10
    v_mfma_f32_16x16x32_bf16 v[100:103], v[164:167], v[152:155], v[100:103]
    v_lshlrev_b32 v241, 4, v240
    v_mfma_f32_16x16x32_bf16 v[104:107], v[168:171], v[152:155], v[104:107]
    v_mov_b32 v251, 0
    v_mfma_f32_16x16x32_bf16 v[108:111], v[172:175], v[152:155], v[108:111]
    buffer_load_dword v250, v251, s[88:91], 0 offen sc1
    v_mfma_f32_16x16x32_bf16 v[112:115], v[160:163], v[156:159], v[112:115]
    v_mfma_f32_16x16x32_bf16 v[116:119], v[164:167], v[156:159], v[116:119]
    v_mfma_f32_16x16x32_bf16 v[120:123], v[168:171], v[156:159], v[120:123]
    v_mfma_f32_16x16x32_bf16 v[124:127], v[172:175], v[156:159], v[124:127]
    s_waitcnt lgkmcnt(0)
    s_barrier
    v_mfma_f32_16x16x32_bf16 v[0:3], v[208:211], v[176:179], v[0:3]
    v_mfma_f32_16x16x32_bf16 v[4:7], v[212:215], v[176:179], v[4:7]
    v_mfma_f32_16x16x32_bf16 v[8:11], v[216:219], v[176:179], v[8:11]
    v_mfma_f32_16x16x32_bf16 v[12:15], v[220:223], v[176:179], v[12:15]
    v_mfma_f32_16x16x32_bf16 v[16:19], v[208:211], v[180:183], v[16:19]
    v_mfma_f32_16x16x32_bf16 v[20:23], v[212:215], v[180:183], v[20:23]
    v_mfma_f32_16x16x32_bf16 v[24:27], v[216:219], v[180:183], v[24:27]
    v_mfma_f32_16x16x32_bf16 v[28:31], v[220:223], v[180:183], v[28:31]
    v_mfma_f32_16x16x32_bf16 v[32:35], v[208:211], v[184:187], v[32:35]
    v_cvt_pk_bf16_f32 v128, v0, v1
    v_cvt_pk_bf16_f32 v129, v2, v3
    v_cvt_pk_bf16_f32 v130, v4, v5
    v_cvt_pk_bf16_f32 v131, v6, v7
    v_pk_max_i16 v128, v128, 0
    v_mfma_f32_16x16x32_bf16 v[36:39], v[212:215], v[184:187], v[36:39]
    v_pk_max_i16 v129, v129, 0
    v_pk_max_i16 v130, v130, 0
    v_pk_max_i16 v131, v131, 0
    buffer_store_dwordx4 v[128:131], v241, s[20:23], s34 offen offset:0 sc1
    v_cvt_pk_bf16_f32 v132, v8, v9
    v_mfma_f32_16x16x32_bf16 v[40:43], v[216:219], v[184:187], v[40:43]
    v_cvt_pk_bf16_f32 v133, v10, v11
    v_cvt_pk_bf16_f32 v134, v12, v13
    v_cvt_pk_bf16_f32 v135, v14, v15
    v_pk_max_i16 v132, v132, 0
    v_pk_max_i16 v133, v133, 0
    v_mfma_f32_16x16x32_bf16 v[44:47], v[220:223], v[184:187], v[44:47]
    v_pk_max_i16 v134, v134, 0
    v_pk_max_i16 v135, v135, 0
    buffer_store_dwordx4 v[132:135], v241, s[20:23], s34 offen offset:1024 sc1
    s_add_u32 s34, s34, 114688
    v_mfma_f32_16x16x32_bf16 v[48:51], v[208:211], v[188:191], v[48:51]
    v_cvt_pk_bf16_f32 v136, v16, v17
    v_cvt_pk_bf16_f32 v137, v18, v19
    v_cvt_pk_bf16_f32 v138, v20, v21
    v_cvt_pk_bf16_f32 v139, v22, v23
    v_pk_max_i16 v136, v136, 0
    v_mfma_f32_16x16x32_bf16 v[52:55], v[212:215], v[188:191], v[52:55]
    v_pk_max_i16 v137, v137, 0
    v_pk_max_i16 v138, v138, 0
    v_pk_max_i16 v139, v139, 0
    buffer_store_dwordx4 v[136:139], v241, s[20:23], s34 offen offset:0 sc1
    v_cvt_pk_bf16_f32 v140, v24, v25
    v_mfma_f32_16x16x32_bf16 v[56:59], v[216:219], v[188:191], v[56:59]
    v_cvt_pk_bf16_f32 v141, v26, v27
    v_cvt_pk_bf16_f32 v142, v28, v29
    v_cvt_pk_bf16_f32 v143, v30, v31
    v_pk_max_i16 v140, v140, 0
    v_pk_max_i16 v141, v141, 0
    v_mfma_f32_16x16x32_bf16 v[60:63], v[220:223], v[188:191], v[60:63]
    v_pk_max_i16 v142, v142, 0
    v_pk_max_i16 v143, v143, 0
    buffer_store_dwordx4 v[140:143], v241, s[20:23], s34 offen offset:1024 sc1
    s_add_u32 s34, s34, 114688
    v_mfma_f32_16x16x32_bf16 v[64:67], v[208:211], v[192:195], v[64:67]
    v_cvt_pk_bf16_f32 v144, v32, v33
    v_cvt_pk_bf16_f32 v145, v34, v35
    v_cvt_pk_bf16_f32 v146, v36, v37
    v_cvt_pk_bf16_f32 v147, v38, v39
    v_pk_max_i16 v144, v144, 0
    v_mfma_f32_16x16x32_bf16 v[68:71], v[212:215], v[192:195], v[68:71]
    v_pk_max_i16 v145, v145, 0
    v_pk_max_i16 v146, v146, 0
    v_pk_max_i16 v147, v147, 0
    buffer_store_dwordx4 v[144:147], v241, s[20:23], s34 offen offset:0 sc1
    v_cvt_pk_bf16_f32 v148, v40, v41
    v_mfma_f32_16x16x32_bf16 v[72:75], v[216:219], v[192:195], v[72:75]
    v_cvt_pk_bf16_f32 v149, v42, v43
    v_cvt_pk_bf16_f32 v150, v44, v45
    v_cvt_pk_bf16_f32 v151, v46, v47
    v_pk_max_i16 v148, v148, 0
    v_pk_max_i16 v149, v149, 0
    v_mfma_f32_16x16x32_bf16 v[76:79], v[220:223], v[192:195], v[76:79]
    v_pk_max_i16 v150, v150, 0
    v_pk_max_i16 v151, v151, 0
    buffer_store_dwordx4 v[148:151], v241, s[20:23], s34 offen offset:1024 sc1
    s_add_u32 s34, s34, 114688
    v_mfma_f32_16x16x32_bf16 v[80:83], v[208:211], v[196:199], v[80:83]
    v_cvt_pk_bf16_f32 v152, v48, v49
    v_cvt_pk_bf16_f32 v153, v50, v51
    v_cvt_pk_bf16_f32 v154, v52, v53
    v_cvt_pk_bf16_f32 v155, v54, v55
    v_pk_max_i16 v152, v152, 0
    v_mfma_f32_16x16x32_bf16 v[84:87], v[212:215], v[196:199], v[84:87]
    v_pk_max_i16 v153, v153, 0
    v_pk_max_i16 v154, v154, 0
    v_pk_max_i16 v155, v155, 0
    buffer_store_dwordx4 v[152:155], v241, s[20:23], s34 offen offset:0 sc1
    v_cvt_pk_bf16_f32 v156, v56, v57
    v_mfma_f32_16x16x32_bf16 v[88:91], v[216:219], v[196:199], v[88:91]
    v_cvt_pk_bf16_f32 v157, v58, v59
    v_cvt_pk_bf16_f32 v158, v60, v61
    v_cvt_pk_bf16_f32 v159, v62, v63
    v_pk_max_i16 v156, v156, 0
    v_pk_max_i16 v157, v157, 0
    v_mfma_f32_16x16x32_bf16 v[92:95], v[220:223], v[196:199], v[92:95]
    v_pk_max_i16 v158, v158, 0
    v_pk_max_i16 v159, v159, 0
    buffer_store_dwordx4 v[156:159], v241, s[20:23], s34 offen offset:1024 sc1
    s_add_u32 s34, s34, 114688
    v_mfma_f32_16x16x32_bf16 v[96:99], v[208:211], v[200:203], v[96:99]
    v_cvt_pk_bf16_f32 v128, v64, v65
    v_cvt_pk_bf16_f32 v129, v66, v67
    v_cvt_pk_bf16_f32 v130, v68, v69
    v_cvt_pk_bf16_f32 v131, v70, v71
    v_pk_max_i16 v128, v128, 0
    v_mfma_f32_16x16x32_bf16 v[100:103], v[212:215], v[200:203], v[100:103]
    v_pk_max_i16 v129, v129, 0
    v_pk_max_i16 v130, v130, 0
    v_pk_max_i16 v131, v131, 0
    buffer_store_dwordx4 v[128:131], v241, s[20:23], s34 offen offset:0 sc1
    v_cvt_pk_bf16_f32 v132, v72, v73
    v_mfma_f32_16x16x32_bf16 v[104:107], v[216:219], v[200:203], v[104:107]
    v_cvt_pk_bf16_f32 v133, v74, v75
    v_cvt_pk_bf16_f32 v134, v76, v77
    v_cvt_pk_bf16_f32 v135, v78, v79
    v_pk_max_i16 v132, v132, 0
    v_pk_max_i16 v133, v133, 0
    v_mfma_f32_16x16x32_bf16 v[108:111], v[220:223], v[200:203], v[108:111]
    v_pk_max_i16 v134, v134, 0
    v_pk_max_i16 v135, v135, 0
    buffer_store_dwordx4 v[132:135], v241, s[20:23], s34 offen offset:1024 sc1
    s_add_u32 s34, s34, 114688
    v_mfma_f32_16x16x32_bf16 v[112:115], v[208:211], v[204:207], v[112:115]
    v_cvt_pk_bf16_f32 v136, v80, v81
    v_cvt_pk_bf16_f32 v137, v82, v83
    v_cvt_pk_bf16_f32 v138, v84, v85
    v_cvt_pk_bf16_f32 v139, v86, v87
    v_pk_max_i16 v136, v136, 0
    v_mfma_f32_16x16x32_bf16 v[116:119], v[212:215], v[204:207], v[116:119]
    v_pk_max_i16 v137, v137, 0
    v_pk_max_i16 v138, v138, 0
    v_pk_max_i16 v139, v139, 0
    buffer_store_dwordx4 v[136:139], v241, s[20:23], s34 offen offset:0 sc1
    v_cvt_pk_bf16_f32 v140, v88, v89
    v_mfma_f32_16x16x32_bf16 v[120:123], v[216:219], v[204:207], v[120:123]
    v_cvt_pk_bf16_f32 v141, v90, v91
    v_cvt_pk_bf16_f32 v142, v92, v93
    v_cvt_pk_bf16_f32 v143, v94, v95
    v_pk_max_i16 v140, v140, 0
    v_pk_max_i16 v141, v141, 0
    v_mfma_f32_16x16x32_bf16 v[124:127], v[220:223], v[204:207], v[124:127]
    v_pk_max_i16 v142, v142, 0
    v_pk_max_i16 v143, v143, 0
    buffer_store_dwordx4 v[140:143], v241, s[20:23], s34 offen offset:1024 sc1
    s_add_u32 s34, s34, 114688
    v_cvt_pk_bf16_f32 v144, v96, v97
    v_cvt_pk_bf16_f32 v145, v98, v99
    v_cvt_pk_bf16_f32 v146, v100, v101
    v_cvt_pk_bf16_f32 v147, v102, v103
    v_pk_max_i16 v144, v144, 0
    v_pk_max_i16 v145, v145, 0
    v_pk_max_i16 v146, v146, 0
    v_pk_max_i16 v147, v147, 0
    buffer_store_dwordx4 v[144:147], v241, s[20:23], s34 offen offset:0 sc1
    v_cvt_pk_bf16_f32 v148, v104, v105
    v_cvt_pk_bf16_f32 v149, v106, v107
    v_cvt_pk_bf16_f32 v150, v108, v109
    v_cvt_pk_bf16_f32 v151, v110, v111
    v_pk_max_i16 v148, v148, 0
    v_pk_max_i16 v149, v149, 0
    v_pk_max_i16 v150, v150, 0
    v_pk_max_i16 v151, v151, 0
    buffer_store_dwordx4 v[148:151], v241, s[20:23], s34 offen offset:1024 sc1
    s_add_u32 s34, s34, 114688
    v_cvt_pk_bf16_f32 v152, v112, v113
    v_cvt_pk_bf16_f32 v153, v114, v115
    v_cvt_pk_bf16_f32 v154, v116, v117
    v_cvt_pk_bf16_f32 v155, v118, v119
    v_pk_max_i16 v152, v152, 0
    v_pk_max_i16 v153, v153, 0
    v_pk_max_i16 v154, v154, 0
    v_pk_max_i16 v155, v155, 0
    buffer_store_dwordx4 v[152:155], v241, s[20:23], s34 offen offset:0 sc1
    v_cvt_pk_bf16_f32 v156, v120, v121
    v_cvt_pk_bf16_f32 v157, v122, v123
    v_cvt_pk_bf16_f32 v158, v124, v125
    v_cvt_pk_bf16_f32 v159, v126, v127
    v_pk_max_i16 v156, v156, 0
    v_pk_max_i16 v157, v157, 0
    v_pk_max_i16 v158, v158, 0
    v_pk_max_i16 v159, v159, 0
    buffer_store_dwordx4 v[156:159], v241, s[20:23], s34 offen offset:1024 sc1
    s_barrier
    s_branch pb_compute
pb_load:
    s_and_b32 s95, s25, 1
    s_bfe_u32 s94, s25, 0x10001
    s_lshl_b32 s94, s94, 2
    s_and_b32 s29, s26, 3
    s_add_u32 s94, s94, s29
    s_lshr_b32 s93, s25, 2
    s_lshl_b32 s93, s93, 3
    s_lshr_b32 s29, s26, 2
    s_add_u32 s93, s93, s29
    s_add_u32 s80, s10, 25165824
    s_addc_u32 s81, s11, 0
    s_mov_b32 s82, 5242880
    s_mov_b32 s83, 0x20000
    s_cmp_ge_u32 s24, 6
    s_cbranch_scc1 pb_watch
    s_sub_u32 s29, s24, 4
    s_mov_b32 s60, s66
    s_mov_b32 s61, s67
    s_mov_b32 s62, 7340032
    s_mov_b32 s63, 0x20000
    s_add_u32 s76, s10, 16777216
    s_addc_u32 s77, s11, 0
    s_mov_b32 s78, 8388608
    s_mov_b32 s79, 0x20000
    v_lshrrev_b32 v241, 4, v240
    v_and_b32 v242, 15, v240
    v_lshlrev_b32 v243, 1, v241
    v_xor_b32 v242, v242, v243
    v_lshlrev_b32 v242, 4, v242
    v_lshl_add_u32 v3, v241, 8, v242
    v_xor_b32 v4, 128, v3
    v_lshl_add_u32 v242, v241, 11, v242
    s_mul_i32 s30, s95, 3670016
    s_lshl_b32 s31, s94, 8
    s_add_u32 s30, s30, s31
    s_lshl_b32 s31, s29, 16
    s_add_u32 s30, s30, s31
    v_add_u32 v1, s30, v242
    v_xor_b32 v2, 128, v1
    s_mov_b32 s40, 0
    s_mov_b32 s41, 7168
    s_mov_b32 s42, 14336
    s_mov_b32 s43, 21504
    s_mov_b32 s44, 32768
    s_mov_b32 s45, 39936
    s_mov_b32 s46, 47104
    s_mov_b32 s47, 54272
    s_lshl_b32 s37, s29, 13
    s_mov_b32 s34, 0
    s_mov_b32 s35, s37
    s_mov_b32 s33, 0
    s_add_u32 s31, s37, 131072
pb_lpro:
    s_add_u32 m0, s35, 0
    s_add_u32 s48, s34, s40
    buffer_load_dwordx4 v1, s[60:63], s48 offen offset:0  lds
    s_add_u32 s48, s34, s41
    buffer_load_dwordx4 v2, s[60:63], s48 offen offset:1024  lds
    s_add_u32 s48, s34, s42
    buffer_load_dwordx4 v1, s[60:63], s48 offen offset:2048  lds
    s_add_u32 s48, s34, s43
    buffer_load_dwordx4 v2, s[60:63], s48 offen offset:3072  lds
    s_add_u32 m0, s35, 4096
    s_add_u32 s48, s34, s44
    buffer_load_dwordx4 v1, s[60:63], s48 offen offset:0  lds
    s_add_u32 s48, s34, s45
    buffer_load_dwordx4 v2, s[60:63], s48 offen offset:1024  lds
    s_add_u32 s48, s34, s46
    buffer_load_dwordx4 v1, s[60:63], s48 offen offset:2048  lds
    s_add_u32 s48, s34, s47
    buffer_load_dwordx4 v2, s[60:63], s48 offen offset:3072  lds
    s_add_u32 s34, s34, 131072
    s_add_u32 s35, s35, 16384
    s_cmp_eq_u32 s35, s31
    s_cselect_b32 s35, s37, s35
    s_add_u32 s33, s33, 1
    s_cmp_lt_u32 s33, 6
    s_cbranch_scc1 pb_lpro
    s_lshl_b32 s30, s93, 1
    s_add_u32 s30, s30, s95
    s_lshl_b32 s39, s30, 1
    s_lshl_b32 s38, s94, 3
    s_xor_b32 s39, s39, s38
    s_and_b32 s39, s39, 63
    s_lshl_b32 s30, s30, 4
    s_add_u32 s30, s30, s94
    s_lshl_b32 s59, s30, 14
    s_waitcnt vmcnt(48)
    s_barrier
    s_barrier
    s_waitcnt vmcnt(40)
    s_barrier
pb_ldloop:
    s_add_u32 m0, s35, 0
    s_add_u32 s48, s34, s40
    buffer_load_dwordx4 v1, s[60:63], s48 offen offset:0  lds
    s_add_u32 s48, s34, s41
    buffer_load_dwordx4 v2, s[60:63], s48 offen offset:1024  lds
    s_add_u32 s48, s34, s42
    buffer_load_dwordx4 v1, s[60:63], s48 offen offset:2048  lds
    s_add_u32 s48, s34, s43
    buffer_load_dwordx4 v2, s[60:63], s48 offen offset:3072  lds
    s_add_u32 m0, s35, 4096
    s_add_u32 s48, s34, s44
    buffer_load_dwordx4 v1, s[60:63], s48 offen offset:0  lds
    s_add_u32 s48, s34, s45
    buffer_load_dwordx4 v2, s[60:63], s48 offen offset:1024  lds
    s_add_u32 s48, s34, s46
    buffer_load_dwordx4 v1, s[60:63], s48 offen offset:2048  lds
    s_add_u32 s48, s34, s47
    buffer_load_dwordx4 v2, s[60:63], s48 offen offset:3072  lds
    s_add_u32 s34, s34, 131072
    s_add_u32 s35, s35, 16384
    s_cmp_eq_u32 s35, s31
    s_cselect_b32 s35, s37, s35
    s_waitcnt vmcnt(40)
    s_barrier
    s_add_u32 s33, s33, 1
    s_cmp_lt_u32 s33, 28
    s_cbranch_scc1 pb_ldloop
    s_xor_b32 s38, s39, 0
    s_and_b32 s30, s38, 3
    s_lshl_b32 s30, s30, 8
    v_xor_b32 v7, s30, v3
    v_xor_b32 v8, s30, v4
    s_lshl_b32 s30, s29, 5
    s_add_u32 s30, s30, 0
    s_xor_b32 s30, s30, s38
    s_andn2_b32 s30, s30, 3
    s_lshl_b32 s30, s30, 8
    s_add_u32 s30, s30, s59
    s_add_u32 m0, s35, 0
    s_add_u32 s56, s30, 0
    buffer_load_dwordx4 v7, s[76:79], s56 offen offset:0 sc1 lds
    s_lshl_b32 s30, s29, 5
    s_add_u32 s30, s30, 4
    s_xor_b32 s30, s30, s38
    s_andn2_b32 s30, s30, 3
    s_lshl_b32 s30, s30, 8
    s_add_u32 s30, s30, s59
    s_add_u32 s56, s30, 4294966272
    buffer_load_dwordx4 v8, s[76:79], s56 offen offset:1024 sc1 lds
    s_lshl_b32 s30, s29, 5
    s_add_u32 s30, s30, 8
    s_xor_b32 s30, s30, s38
    s_andn2_b32 s30, s30, 3
    s_lshl_b32 s30, s30, 8
    s_add_u32 s30, s30, s59
    s_add_u32 s56, s30, 4294965248
    buffer_load_dwordx4 v7, s[76:79], s56 offen offset:2048 sc1 lds
    s_lshl_b32 s30, s29, 5
    s_add_u32 s30, s30, 12
    s_xor_b32 s30, s30, s38
    s_andn2_b32 s30, s30, 3
    s_lshl_b32 s30, s30, 8
    s_add_u32 s30, s30, s59
    s_add_u32 s56, s30, 4294964224
    buffer_load_dwordx4 v8, s[76:79], s56 offen offset:3072 sc1 lds
    s_lshl_b32 s30, s29, 5
    s_add_u32 s30, s30, 16
    s_xor_b32 s30, s30, s38
    s_andn2_b32 s30, s30, 3
    s_lshl_b32 s30, s30, 8
    s_add_u32 s30, s30, s59
    s_add_u32 m0, s35, 4096
    s_add_u32 s56, s30, 0
    buffer_load_dwordx4 v7, s[76:79], s56 offen offset:0 sc1 lds
    s_lshl_b32 s30, s29, 5
    s_add_u32 s30, s30, 20
    s_xor_b32 s30, s30, s38
    s_andn2_b32 s30, s30, 3
    s_lshl_b32 s30, s30, 8
    s_add_u32 s30, s30, s59
    s_add_u32 s56, s30, 4294966272
    buffer_load_dwordx4 v8, s[76:79], s56 offen offset:1024 sc1 lds
    s_lshl_b32 s30, s29, 5
    s_add_u32 s30, s30, 24
    s_xor_b32 s30, s30, s38
    s_andn2_b32 s30, s30, 3
    s_lshl_b32 s30, s30, 8
    s_add_u32 s30, s30, s59
    s_add_u32 s56, s30, 4294965248
    buffer_load_dwordx4 v7, s[76:79], s56 offen offset:2048 sc1 lds
    s_lshl_b32 s30, s29, 5
    s_add_u32 s30, s30, 28
    s_xor_b32 s30, s30, s38
    s_andn2_b32 s30, s30, 3
    s_lshl_b32 s30, s30, 8
    s_add_u32 s30, s30, s59
    s_add_u32 s56, s30, 4294964224
    buffer_load_dwordx4 v8, s[76:79], s56 offen offset:3072 sc1 lds
    s_add_u32 s34, s34, 131072
    s_add_u32 s35, s35, 16384
    s_cmp_eq_u32 s35, s31
    s_cselect_b32 s35, s37, s35
    s_waitcnt vmcnt(40)
    s_barrier
    s_xor_b32 s38, s39, 1
    s_and_b32 s30, s38, 3
    s_lshl_b32 s30, s30, 8
    v_xor_b32 v7, s30, v3
    v_xor_b32 v8, s30, v4
    s_lshl_b32 s30, s29, 5
    s_add_u32 s30, s30, 0
    s_xor_b32 s30, s30, s38
    s_andn2_b32 s30, s30, 3
    s_lshl_b32 s30, s30, 8
    s_add_u32 s30, s30, s59
    s_add_u32 m0, s35, 0
    s_add_u32 s56, s30, 131072
    buffer_load_dwordx4 v7, s[76:79], s56 offen offset:0 sc1 lds
    s_lshl_b32 s30, s29, 5
    s_add_u32 s30, s30, 4
    s_xor_b32 s30, s30, s38
    s_andn2_b32 s30, s30, 3
    s_lshl_b32 s30, s30, 8
    s_add_u32 s30, s30, s59
    s_add_u32 s56, s30, 130048
    buffer_load_dwordx4 v8, s[76:79], s56 offen offset:1024 sc1 lds
    s_lshl_b32 s30, s29, 5
    s_add_u32 s30, s30, 8
    s_xor_b32 s30, s30, s38
    s_andn2_b32 s30, s30, 3
    s_lshl_b32 s30, s30, 8
    s_add_u32 s30, s30, s59
    s_add_u32 s56, s30, 129024
    buffer_load_dwordx4 v7, s[76:79], s56 offen offset:2048 sc1 lds
    s_lshl_b32 s30, s29, 5
    s_add_u32 s30, s30, 12
    s_xor_b32 s30, s30, s38
    s_andn2_b32 s30, s30, 3
    s_lshl_b32 s30, s30, 8
    s_add_u32 s30, s30, s59
    s_add_u32 s56, s30, 128000
    buffer_load_dwordx4 v8, s[76:79], s56 offen offset:3072 sc1 lds
    s_lshl_b32 s30, s29, 5
    s_add_u32 s30, s30, 16
    s_xor_b32 s30, s30, s38
    s_andn2_b32 s30, s30, 3
    s_lshl_b32 s30, s30, 8
    s_add_u32 s30, s30, s59
    s_add_u32 m0, s35, 4096
    s_add_u32 s56, s30, 131072
    buffer_load_dwordx4 v7, s[76:79], s56 offen offset:0 sc1 lds
    s_lshl_b32 s30, s29, 5
    s_add_u32 s30, s30, 20
    s_xor_b32 s30, s30, s38
    s_andn2_b32 s30, s30, 3
    s_lshl_b32 s30, s30, 8
    s_add_u32 s30, s30, s59
    s_add_u32 s56, s30, 130048
    buffer_load_dwordx4 v8, s[76:79], s56 offen offset:1024 sc1 lds
    s_lshl_b32 s30, s29, 5
    s_add_u32 s30, s30, 24
    s_xor_b32 s30, s30, s38
    s_andn2_b32 s30, s30, 3
    s_lshl_b32 s30, s30, 8
    s_add_u32 s30, s30, s59
    s_add_u32 s56, s30, 129024
    buffer_load_dwordx4 v7, s[76:79], s56 offen offset:2048 sc1 lds
    s_lshl_b32 s30, s29, 5
    s_add_u32 s30, s30, 28
    s_xor_b32 s30, s30, s38
    s_andn2_b32 s30, s30, 3
    s_lshl_b32 s30, s30, 8
    s_add_u32 s30, s30, s59
    s_add_u32 s56, s30, 128000
    buffer_load_dwordx4 v8, s[76:79], s56 offen offset:3072 sc1 lds
    s_add_u32 s34, s34, 131072
    s_add_u32 s35, s35, 16384
    s_cmp_eq_u32 s35, s31
    s_cselect_b32 s35, s37, s35
    s_waitcnt vmcnt(40)
    s_barrier
    s_waitcnt vmcnt(32)
    s_barrier
    s_waitcnt vmcnt(24)
    s_barrier
    s_waitcnt vmcnt(16)
    s_barrier
    s_waitcnt vmcnt(8)
    s_barrier
    s_waitcnt vmcnt(0)
    s_barrier
    s_endpgm
pb_watch:
    s_mov_b32 s72, s66
    s_mov_b32 s73, s67
    s_mov_b32 s74, 7340032
    s_mov_b32 s75, 0x20000
    s_lshr_b32 s30, s2, 1
    s_lshr_b32 s31, s30, 1
    s_lshl_b32 s31, s31, 11
    s_and_b32 s30, s30, 1
    s_lshl_b32 s30, s30, 10
    s_add_u32 s30, s30, s31
    s_mul_i32 s31, s95, 3670016
    s_add_u32 s30, s30, s31
    v_lshrrev_b32 v20, 3, v240
    v_lshlrev_b32 v20, 17, v20
    v_and_b32 v21, 7, v240
    v_lshl_add_u32 v20, v21, 7, v20
    v_add_u32 v20, s30, v20
    s_waitcnt vmcnt(0)
pb_watch_e1:
    s_barrier
    v_mov_b32 v6, 147456
    ds_read_b32 v6, v6
    s_waitcnt lgkmcnt(0)
    v_readfirstlane_b32 s92, v6
    s_cmp_eq_u32 s24, 7
    s_cbranch_scc1 pb_watch_f
    s_lshr_b32 s30, s93, 1
    s_mul_i32 s30, s30, 28
    s_mul_i32 s31, s95, 14
    s_add_u32 s30, s30, s31
    s_lshl_b32 s30, s30, 2
    s_and_b32 s31, s93, 1
    s_add_u32 s30, s30, s31
    v_min_u32 v5, 27, v240
    v_lshlrev_b32 v5, 1, v5
    v_add_u32 v5, s30, v5
    v_lshlrev_b32 v5, 7, v5
    v_add_u32 v5, 16384, v5
    s_mov_b32 s44, 0
    s_mov_b32 s46, 15
    s_mov_b32 s57, 65536
pb_need_a:
    s_and_b32 s45, s44, s46
    s_cmp_eq_u32 s45, s46
    s_cbranch_scc1 pb_need_a_ok
    s_sub_u32 s57, s57, 1
    s_cmp_eq_u32 s57, 0
    s_cbranch_scc1 pb_need_a_ok
    buffer_load_dword v9, v5, s[80:83], 0 offen sc1
    s_waitcnt vmcnt(0)
    v_cmp_eq_u32 vcc, s92, v9
    s_nop 3
    s_or_b32 s44, s44, vcc_lo
    s_branch pb_need_a
pb_need_a_ok:
    s_barrier
    buffer_load_dword v10, v5, s[80:83], 0 offen sc1
    s_barrier
    s_mov_b32 s33, 1
pb_hw_loop:
    s_and_b32 s45, s44, 0xfffffff
    s_cmp_eq_u32 s45, 0xfffffff
    s_cbranch_scc1 pb_hw_bar
    s_bitcmp1_b32 s33, 0
    s_cbranch_scc0 pb_hw_req
    s_waitcnt vmcnt(0)
    v_cmp_eq_u32 vcc, s92, v10
    s_nop 3
    s_or_b32 s44, s44, vcc_lo
    buffer_load_dword v10, v5, s[80:83], 0 offen sc1
pb_hw_req:
    s_lshl_b32 s46, s33, 1
    s_add_u32 s46, s46, 7
    s_lshr_b32 s46, s46, 2
    s_min_u32 s46, s46, 13
    s_lshl_b32 s46, s46, 1
    s_lshl_b32 s46, 4, s46
    s_sub_u32 s46, s46, 1
    s_mov_b32 s57, 65536
pb_need_b:
    s_and_b32 s45, s44, s46
    s_cmp_eq_u32 s45, s46
    s_cbranch_scc1 pb_need_b_ok
    s_sub_u32 s57, s57, 1
    s_cmp_eq_u32 s57, 0
    s_cbranch_scc1 pb_need_b_ok
    buffer_load_dword v9, v5, s[80:83], 0 offen sc1
    s_waitcnt vmcnt(0)
    v_cmp_eq_u32 vcc, s92, v9
    s_nop 3
    s_or_b32 s44, s44, vcc_lo
    s_branch pb_need_b
pb_need_b_ok:
pb_hw_bar:
    s_barrier
    s_add_u32 s33, s33, 1
    s_cmp_lt_u32 s33, 30
    s_cbranch_scc1 pb_hw_loop
    s_endpgm
pb_watch_f:
    s_mov_b32 s47, 1835008
    buffer_load_dword v21, v20, s[72:75], s47 offen
    v_min_u32 v5, 31, v240
    v_lshlrev_b32 v5, 7, v5
    v_add_u32 v5, 8192, v5
    s_barrier
    s_barrier
    s_mov_b32 s33, 1
pb_fw_loop:
    s_cmp_lg_u32 s33, 5
    s_cbranch_scc1 pb_fw_nopf5
    s_mov_b32 s47, 2883584
    buffer_load_dword v21, v20, s[72:75], s47 offen
pb_fw_nopf5:
    s_cmp_lg_u32 s33, 18
    s_cbranch_scc1 pb_fw_noreq
    buffer_load_dword v6, v5, s[80:83], 0 offen sc1
pb_fw_noreq:
    s_cmp_lg_u32 s33, 12
    s_cbranch_scc1 pb_fw_nocpf
    s_getpc_b64 s[48:49]
cpf_1347:
    s_add_u32 s48, s48, pb_loop-cpf_1347
    s_addc_u32 s49, s49, 0
    s_mov_b32 s50, k_fft-pb_loop-4
    v_lshlrev_b32 v14, 7, v240
    v_min_u32 v14, s50, v14
    v_and_b32 v14, -4, v14
    global_load_dword v15, v14, s[48:49]
pb_fw_nocpf:
    s_cmp_lg_u32 s33, 21
    s_cbranch_scc1 pb_fw_bar
    s_waitcnt vmcnt(0)
    v_cmp_ne_u32 vcc, s92, v6
    s_nop 3
    s_cmp_eq_u32 vcc_lo, 0
    s_cbranch_scc1 pb_fw_bar
    s_mov_b32 s57, 65536
pb_fpoll:
    buffer_load_dword v6, v5, s[80:83], 0 offen sc1
    s_sub_u32 s57, s57, 1
    s_waitcnt vmcnt(0)
    v_cmp_ne_u32 vcc, s92, v6
    s_cmp_eq_u32 s57, 0
    s_cbranch_scc1 pb_fpoll_done
    s_and_b32 s58, vcc_lo, 0xffffffff
    s_cbranch_scc1 pb_fpoll
pb_fpoll_done:
pb_fw_bar:
    s_barrier
    s_add_u32 s33, s33, 1
    s_cmp_lt_u32 s33, 30
    s_cbranch_scc1 pb_fw_loop
    s_endpgm
pb_compute:
    s_and_b32 s95, s25, 1
    s_bfe_u32 s94, s25, 0x10001
    s_lshl_b32 s94, s94, 2
    s_and_b32 s29, s26, 3
    s_add_u32 s94, s94, s29
    s_lshr_b32 s93, s25, 2
    s_lshl_b32 s93, s93, 3
    s_lshr_b32 s29, s26, 2
    s_add_u32 s93, s93, s29
    s_add_u32 s80, s10, 25165824
    s_addc_u32 s81, s11, 0
    s_mov_b32 s82, 5242880
    s_mov_b32 s83, 0x20000
    s_mov_b32 s20, s10
    s_mov_b32 s21, s11
    s_mov_b32 s22, 14680064
    s_mov_b32 s23, 0x20000
    s_xor_b32 s30, s95, 0
    s_lshl_b32 s30, s30, 2
    s_lshl_b32 s31, s93, 3
    s_add_u32 s30, s30, s31
    s_add_u32 s30, s30, s24
    s_mul_i32 s30, s30, 112
    s_mul_i32 s31, s95, 56
    s_add_u32 s30, s30, s31
    s_lshl_b32 s30, s30, 10
    v_lshl_add_u32 v241, v240, 4, s30
    s_xor_b32 s30, s95, 1
    s_lshl_b32 s30, s30, 2
    s_lshl_b32 s31, s93, 3
    s_add_u32 s30, s30, s31
    s_add_u32 s30, s30, s24
    s_mul_i32 s30, s30, 112
    s_mul_i32 s31, s95, 56
    s_add_u32 s30, s30, s31
    s_lshl_b32 s30, s30, 10
    v_lshl_add_u32 v242, v240, 4, s30
    v_lshrrev_b32 v244, 4, v240
    v_bfe_u32 v243, v240, 2, 2
    v_and_b32 v245, 1, v244
    v_lshl_add_u32 v245, v245, 2, v243
    v_lshl_add_u32 v246, v244, 2, v243
    v_lshlrev_b32 v246, 8, v246
    v_and_b32 v247, 1, v240
    v_lshl_add_u32 v246, v247, 3, v246
    v_bfe_u32 v247, v240, 1, 1
    v_lshlrev_b32 v245, 1, v245
    v_xor_b32 v247, v247, v245
    v_xor_b32 v243, 0, v247
    v_lshl_add_u32 v232, v243, 4, v246
    v_xor_b32 v243, 2, v247
    v_lshl_add_u32 v233, v243, 4, v246
    v_xor_b32 v243, 4, v247
    v_lshl_add_u32 v234, v243, 4, v246
    v_xor_b32 v243, 6, v247
    v_lshl_add_u32 v235, v243, 4, v246
    v_xor_b32 v243, 8, v247
    v_lshl_add_u32 v236, v243, 4, v246
    v_xor_b32 v243, 10, v247
    v_lshl_add_u32 v237, v243, 4, v246
    v_xor_b32 v243, 12, v247
    v_lshl_add_u32 v238, v243, 4, v246
    v_xor_b32 v243, 14, v247
    v_lshl_add_u32 v239, v243, 4, v246
    v_and_b32 v243, 15, v240
    v_lshrrev_b32 v244, 4, v240
    s_lshl_b32 s31, s24, 4
    v_add_u32 v243, s31, v243
    v_cvt_f32_u32 v64, v243
    v_mul_f32 v64, 0x3c800000, v64
    v_cvt_f32_u32 v65, v244
    v_mul_f32 v65, 4.0, v65
    v_mul_f32 v65, v65, v64
    v_mul_f32 v66, 0x41800000, v64
    s_lshl_b32 s31, s24, 11
    s_add_u32 s31, s31, 131072
    v_lshl_add_u32 v67, v240, 4, s31
    v_mov_b32 v68, v65
    v_add_f32 v69, v68, v64
    v_add_f32 v70, v69, v64
    v_add_f32 v71, v70, v64
    v_sin_f32 v72, v68
    v_sin_f32 v73, v69
    v_sin_f32 v74, v70
    v_sin_f32 v75, v71
    v_cos_f32 v68, v68
    v_cos_f32 v69, v69
    v_cos_f32 v70, v70
    v_cos_f32 v71, v71
    v_sub_f32 v72, 0, v72
    v_sub_f32 v73, 0, v73
    v_sub_f32 v74, 0, v74
    v_sub_f32 v75, 0, v75
    v_cvt_pk_bf16_f32 v76, v68, v69
    v_cvt_pk_bf16_f32 v77, v70, v71
    v_cvt_pk_bf16_f32 v84, v72, v73
    v_cvt_pk_bf16_f32 v85, v74, v75
    v_add_f32 v65, v65, v66
    v_mov_b32 v68, v65
    v_add_f32 v69, v68, v64
    v_add_f32 v70, v69, v64
    v_add_f32 v71, v70, v64
    v_sin_f32 v72, v68
    v_sin_f32 v73, v69
    v_sin_f32 v74, v70
    v_sin_f32 v75, v71
    v_cos_f32 v68, v68
    v_cos_f32 v69, v69
    v_cos_f32 v70, v70
    v_cos_f32 v71, v71
    v_sub_f32 v72, 0, v72
    v_sub_f32 v73, 0, v73
    v_sub_f32 v74, 0, v74
    v_sub_f32 v75, 0, v75
    v_cvt_pk_bf16_f32 v78, v68, v69
    v_cvt_pk_bf16_f32 v79, v70, v71
    v_cvt_pk_bf16_f32 v86, v72, v73
    v_cvt_pk_bf16_f32 v87, v74, v75
    v_add_f32 v65, v65, v66
    v_mov_b32 v68, v65
    v_add_f32 v69, v68, v64
    v_add_f32 v70, v69, v64
    v_add_f32 v71, v70, v64
    v_sin_f32 v72, v68
    v_sin_f32 v73, v69
    v_sin_f32 v74, v70
    v_sin_f32 v75, v71
    v_cos_f32 v68, v68
    v_cos_f32 v69, v69
    v_cos_f32 v70, v70
    v_cos_f32 v71, v71
    v_sub_f32 v72, 0, v72
    v_sub_f32 v73, 0, v73
    v_sub_f32 v74, 0, v74
    v_sub_f32 v75, 0, v75
    v_cvt_pk_bf16_f32 v80, v68, v69
    v_cvt_pk_bf16_f32 v81, v70, v71
    v_cvt_pk_bf16_f32 v88, v72, v73
    v_cvt_pk_bf16_f32 v89, v74, v75
    v_add_f32 v65, v65, v66
    v_mov_b32 v68, v65
    v_add_f32 v69, v68, v64
    v_add_f32 v70, v69, v64
    v_add_f32 v71, v70, v64
    v_sin_f32 v72, v68
    v_sin_f32 v73, v69
    v_sin_f32 v74, v70
    v_sin_f32 v75, v71
    v_cos_f32 v68, v68
    v_cos_f32 v69, v69
    v_cos_f32 v70, v70
    v_cos_f32 v71, v71
    v_sub_f32 v72, 0, v72
    v_sub_f32 v73, 0, v73
    v_sub_f32 v74, 0, v74
    v_sub_f32 v75, 0, v75
    v_cvt_pk_bf16_f32 v82, v68, v69
    v_cvt_pk_bf16_f32 v83, v70, v71
    v_cvt_pk_bf16_f32 v90, v72, v73
    v_cvt_pk_bf16_f32 v91, v74, v75
    ds_write_b128 v67, v[76:79]
    ds_write_b128 v67, v[80:83] offset:1024
    ds_write_b128 v67, v[84:87] offset:8192
    ds_write_b128 v67, v[88:91] offset:9216
    v_mov_b32 v0, 0
    v_mov_b32 v1, 0
    v_mov_b32 v2, 0
    v_mov_b32 v3, 0
    v_mov_b32 v4, 0
    v_mov_b32 v5, 0
    v_mov_b32 v6, 0
    v_mov_b32 v7, 0
    v_mov_b32 v8, 0
    v_mov_b32 v9, 0
    v_mov_b32 v10, 0
    v_mov_b32 v11, 0
    v_mov_b32 v12, 0
    v_mov_b32 v13, 0
    v_mov_b32 v14, 0
    v_mov_b32 v15, 0
    v_mov_b32 v16, 0
    v_mov_b32 v17, 0
    v_mov_b32 v18, 0
    v_mov_b32 v19, 0
    v_mov_b32 v20, 0
    v_mov_b32 v21, 0
    v_mov_b32 v22, 0
    v_mov_b32 v23, 0
    v_mov_b32 v24, 0
    v_mov_b32 v25, 0
    v_mov_b32 v26, 0
    v_mov_b32 v27, 0
    v_mov_b32 v28, 0
    v_mov_b32 v29, 0
    v_mov_b32 v30, 0
    v_mov_b32 v31, 0
    v_mov_b32 v32, 0
    v_mov_b32 v33, 0
    v_mov_b32 v34, 0
    v_mov_b32 v35, 0
    v_mov_b32 v36, 0
    v_mov_b32 v37, 0
    v_mov_b32 v38, 0
    v_mov_b32 v39, 0
    v_mov_b32 v40, 0
    v_mov_b32 v41, 0
    v_mov_b32 v42, 0
    v_mov_b32 v43, 0
    v_mov_b32 v44, 0
    v_mov_b32 v45, 0
    v_mov_b32 v46, 0
    v_mov_b32 v47, 0
    v_mov_b32 v48, 0
    v_mov_b32 v49, 0
    v_mov_b32 v50, 0
    v_mov_b32 v51, 0
    v_mov_b32 v52, 0
    v_mov_b32 v53, 0
    v_mov_b32 v54, 0
    v_mov_b32 v55, 0
    v_mov_b32 v56, 0
    v_mov_b32 v57, 0
    v_mov_b32 v58, 0
    v_mov_b32 v59, 0
    v_mov_b32 v60, 0
    v_mov_b32 v61, 0
    v_mov_b32 v62, 0
    v_mov_b32 v63, 0
    s_waitcnt vmcnt(0) lgkmcnt(0)
    v_mov_b32 v251, 0
    s_mov_b32 s57, 65536
nonce_poll_pb:
    v_readfirstlane_b32 s58, v250
    s_sub_u32 s57, s57, 1
    s_cmp_lg_u32 s58, 0
    s_cbranch_scc1 nonce_ok_pb
    s_cmp_eq_u32 s57, 0
    s_cbranch_scc1 nonce_ok_pb
    buffer_load_dword v250, v251, s[88:91], 0 offen sc1
    s_waitcnt vmcnt(0)
    s_branch nonce_poll_pb
nonce_ok_pb:
    s_mov_b32 s92, s58
    v_mov_b32 v251, s96
    s_cmp_ge_u32 s26, 28
    s_cbranch_scc1 pb_c_nowf
    buffer_store_dword v250, v251, s[80:83], 0 offen sc1
pb_c_nowf:
    s_cmp_lg_u32 s24, 0
    s_cbranch_scc1 pb_c_e1
    v_mov_b32 v249, 147456
    ds_write_b32 v249, v250
pb_c_e1:
    s_waitcnt lgkmcnt(0)
    s_barrier
    s_cmp_lg_u32 s24, 0
    s_cbranch_scc1 pb_c_noflag
    s_cmp_lt_u32 s26, 28
    s_cbranch_scc1 pb_c_noflag
    buffer_store_dword v250, v251, s[80:83], 0 offen sc1
pb_c_noflag:
    s_barrier
    s_mov_b32 s34, 0
    buffer_load_dwordx4 v[128:131], v241, s[20:23], s34 offen sc1
    buffer_load_dwordx4 v[132:135], v242, s[20:23], s34 offen sc1
    s_add_u32 s34, s34, 1024
    buffer_load_dwordx4 v[136:139], v241, s[20:23], s34 offen sc1
    buffer_load_dwordx4 v[140:143], v242, s[20:23], s34 offen sc1
    s_add_u32 s34, s34, 1024
    buffer_load_dwordx4 v[144:147], v241, s[20:23], s34 offen sc1
    buffer_load_dwordx4 v[148:151], v242, s[20:23], s34 offen sc1
    s_add_u32 s34, s34, 1024
    buffer_load_dwordx4 v[152:155], v241, s[20:23], s34 offen sc1
    buffer_load_dwordx4 v[156:159], v242, s[20:23], s34 offen sc1
    s_add_u32 s34, s34, 1024
    buffer_load_dwordx4 v[160:163], v241, s[20:23], s34 offen sc1
    buffer_load_dwordx4 v[164:167], v242, s[20:23], s34 offen sc1
    s_add_u32 s34, s34, 1024
    buffer_load_dwordx4 v[168:171], v241, s[20:23], s34 offen sc1
    buffer_load_dwordx4 v[172:175], v242, s[20:23], s34 offen sc1
    s_add_u32 s34, s34, 1024
    buffer_load_dwordx4 v[176:179], v241, s[20:23], s34 offen sc1
    buffer_load_dwordx4 v[180:183], v242, s[20:23], s34 offen sc1
    s_add_u32 s34, s34, 1024
    s_mov_b32 s33, 7
    s_mov_b32 s35, 0x7f000000
    s_waitcnt lgkmcnt(0)
    s_barrier
    ds_read_b64_tr_b16 v[64:65], v232 offset:0
    ds_read_b64_tr_b16 v[66:67], v232 offset:4096
    ds_read_b64_tr_b16 v[68:69], v233 offset:0
    ds_read_b64_tr_b16 v[70:71], v233 offset:4096
    ds_read_b64_tr_b16 v[72:73], v234 offset:0
    ds_read_b64_tr_b16 v[74:75], v234 offset:4096
    ds_read_b64_tr_b16 v[76:77], v235 offset:0
    ds_read_b64_tr_b16 v[78:79], v235 offset:4096
    ds_read_b64_tr_b16 v[80:81], v236 offset:0
    ds_read_b64_tr_b16 v[82:83], v236 offset:4096
    ds_read_b64_tr_b16 v[84:85], v237 offset:0
    ds_read_b64_tr_b16 v[86:87], v237 offset:4096
    ds_read_b64_tr_b16 v[88:89], v238 offset:0
    ds_read_b64_tr_b16 v[90:91], v238 offset:4096
    ds_read_b64_tr_b16 v[92:93], v239 offset:0
    ds_read_b64_tr_b16 v[94:95], v239 offset:4096
    s_waitcnt vmcnt(12) lgkmcnt(12)
pb_loop:
    v_mfma_f32_16x16x32_bf16 v[0:3], v[64:67], v[128:131], v[0:3]
    ds_read_b64_tr_b16 v[96:97], v232 offset:8192
    v_mfma_f32_16x16x32_bf16 v[32:35], v[64:67], v[132:135], v[32:35]
    ds_read_b64_tr_b16 v[98:99], v232 offset:12288
    buffer_load_dwordx4 v[184:187], v241, s[20:23], s34 offen sc1
    v_mfma_f32_16x16x32_bf16 v[4:7], v[68:71], v[128:131], v[4:7]
    ds_read_b64_tr_b16 v[100:101], v233 offset:8192
    v_mfma_f32_16x16x32_bf16 v[36:39], v[68:71], v[132:135], v[36:39]
    ds_read_b64_tr_b16 v[102:103], v233 offset:12288
    s_waitcnt lgkmcnt(12)
    v_mfma_f32_16x16x32_bf16 v[8:11], v[72:75], v[128:131], v[8:11]
    ds_read_b64_tr_b16 v[104:105], v234 offset:8192
    v_mfma_f32_16x16x32_bf16 v[40:43], v[72:75], v[132:135], v[40:43]
    ds_read_b64_tr_b16 v[106:107], v234 offset:12288
    buffer_load_dwordx4 v[188:191], v242, s[20:23], s34 offen sc1
    v_mfma_f32_16x16x32_bf16 v[12:15], v[76:79], v[128:131], v[12:15]
    ds_read_b64_tr_b16 v[108:109], v235 offset:8192
    v_mfma_f32_16x16x32_bf16 v[44:47], v[76:79], v[132:135], v[44:47]
    ds_read_b64_tr_b16 v[110:111], v235 offset:12288
    s_waitcnt lgkmcnt(12)
    v_mfma_f32_16x16x32_bf16 v[16:19], v[80:83], v[128:131], v[16:19]
    ds_read_b64_tr_b16 v[112:113], v236 offset:8192
    v_mfma_f32_16x16x32_bf16 v[48:51], v[80:83], v[132:135], v[48:51]
    ds_read_b64_tr_b16 v[114:115], v236 offset:12288
    s_add_u32 s34, s34, 1024
    v_mfma_f32_16x16x32_bf16 v[20:23], v[84:87], v[128:131], v[20:23]
    ds_read_b64_tr_b16 v[116:117], v237 offset:8192
    s_cmp_eq_u32 s33, 1
    v_mfma_f32_16x16x32_bf16 v[52:55], v[84:87], v[132:135], v[52:55]
    ds_read_b64_tr_b16 v[118:119], v237 offset:12288
    s_waitcnt lgkmcnt(12)
    v_mfma_f32_16x16x32_bf16 v[24:27], v[88:91], v[128:131], v[24:27]
    ds_read_b64_tr_b16 v[120:121], v238 offset:8192
    s_cselect_b32 s34, s35, s34
    v_mfma_f32_16x16x32_bf16 v[56:59], v[88:91], v[132:135], v[56:59]
    ds_read_b64_tr_b16 v[122:123], v238 offset:12288
    v_mfma_f32_16x16x32_bf16 v[28:31], v[92:95], v[128:131], v[28:31]
    ds_read_b64_tr_b16 v[124:125], v239 offset:8192
    s_waitcnt vmcnt(12)
    v_mfma_f32_16x16x32_bf16 v[60:63], v[92:95], v[132:135], v[60:63]
    ds_read_b64_tr_b16 v[126:127], v239 offset:12288
    s_waitcnt lgkmcnt(12)
    v_mfma_f32_16x16x32_bf16 v[0:3], v[96:99], v[136:139], v[0:3]
    s_barrier
    ds_read_b64_tr_b16 v[64:65], v232 offset:16384
    v_mfma_f32_16x16x32_bf16 v[32:35], v[96:99], v[140:143], v[32:35]
    ds_read_b64_tr_b16 v[66:67], v232 offset:20480
    buffer_load_dwordx4 v[128:131], v241, s[20:23], s34 offen sc1
    v_mfma_f32_16x16x32_bf16 v[4:7], v[100:103], v[136:139], v[4:7]
    ds_read_b64_tr_b16 v[68:69], v233 offset:16384
    v_mfma_f32_16x16x32_bf16 v[36:39], v[100:103], v[140:143], v[36:39]
    ds_read_b64_tr_b16 v[70:71], v233 offset:20480
    s_waitcnt lgkmcnt(12)
    v_mfma_f32_16x16x32_bf16 v[8:11], v[104:107], v[136:139], v[8:11]
    ds_read_b64_tr_b16 v[72:73], v234 offset:16384
    v_mfma_f32_16x16x32_bf16 v[40:43], v[104:107], v[140:143], v[40:43]
    ds_read_b64_tr_b16 v[74:75], v234 offset:20480
    buffer_load_dwordx4 v[132:135], v242, s[20:23], s34 offen sc1
    v_mfma_f32_16x16x32_bf16 v[12:15], v[108:111], v[136:139], v[12:15]
    ds_read_b64_tr_b16 v[76:77], v235 offset:16384
    v_mfma_f32_16x16x32_bf16 v[44:47], v[108:111], v[140:143], v[44:47]
    ds_read_b64_tr_b16 v[78:79], v235 offset:20480
    s_waitcnt lgkmcnt(12)
    v_mfma_f32_16x16x32_bf16 v[16:19], v[112:115], v[136:139], v[16:19]
    ds_read_b64_tr_b16 v[80:81], v236 offset:16384
    v_mfma_f32_16x16x32_bf16 v[48:51], v[112:115], v[140:143], v[48:51]
    ds_read_b64_tr_b16 v[82:83], v236 offset:20480
    s_add_u32 s34, s34, 1024
    v_mfma_f32_16x16x32_bf16 v[20:23], v[116:119], v[136:139], v[20:23]
    ds_read_b64_tr_b16 v[84:85], v237 offset:16384
    v_mfma_f32_16x16x32_bf16 v[52:55], v[116:119], v[140:143], v[52:55]
    ds_read_b64_tr_b16 v[86:87], v237 offset:20480
    s_waitcnt lgkmcnt(12)
    v_mfma_f32_16x16x32_bf16 v[24:27], v[120:123], v[136:139], v[24:27]
    ds_read_b64_tr_b16 v[88:89], v238 offset:16384
    v_mfma_f32_16x16x32_bf16 v[56:59], v[120:123], v[140:143], v[56:59]
    ds_read_b64_tr_b16 v[90:91], v238 offset:20480
    v_mfma_f32_16x16x32_bf16 v[28:31], v[124:127], v[136:139], v[28:31]
    ds_read_b64_tr_b16 v[92:93], v239 offset:16384
    s_waitcnt vmcnt(12)
    v_mfma_f32_16x16x32_bf16 v[60:63], v[124:127], v[140:143], v[60:63]
    ds_read_b64_tr_b16 v[94:95], v239 offset:20480
    s_waitcnt lgkmcnt(12)
    v_mfma_f32_16x16x32_bf16 v[0:3], v[64:67], v[144:147], v[0:3]
    ds_read_b64_tr_b16 v[96:97], v232 offset:24576
    v_mfma_f32_16x16x32_bf16 v[32:35], v[64:67], v[148:151], v[32:35]
    ds_read_b64_tr_b16 v[98:99], v232 offset:28672
    buffer_load_dwordx4 v[136:139], v241, s[20:23], s34 offen sc1
    v_mfma_f32_16x16x32_bf16 v[4:7], v[68:71], v[144:147], v[4:7]
    ds_read_b64_tr_b16 v[100:101], v233 offset:24576
    v_mfma_f32_16x16x32_bf16 v[36:39], v[68:71], v[148:151], v[36:39]
    ds_read_b64_tr_b16 v[102:103], v233 offset:28672
    s_waitcnt lgkmcnt(12)
    v_mfma_f32_16x16x32_bf16 v[8:11], v[72:75], v[144:147], v[8:11]
    ds_read_b64_tr_b16 v[104:105], v234 offset:24576
    v_mfma_f32_16x16x32_bf16 v[40:43], v[72:75], v[148:151], v[40:43]
    ds_read_b64_tr_b16 v[106:107], v234 offset:28672
    buffer_load_dwordx4 v[140:143], v242, s[20:23], s34 offen sc1
    v_mfma_f32_16x16x32_bf16 v[12:15], v[76:79], v[144:147], v[12:15]
    ds_read_b64_tr_b16 v[108:109], v235 offset:24576
    v_mfma_f32_16x16x32_bf16 v[44:47], v[76:79], v[148:151], v[44:47]
    ds_read_b64_tr_b16 v[110:111], v235 offset:28672
    s_waitcnt lgkmcnt(12)
    v_mfma_f32_16x16x32_bf16 v[16:19], v[80:83], v[144:147], v[16:19]
    ds_read_b64_tr_b16 v[112:113], v236 offset:24576
    v_mfma_f32_16x16x32_bf16 v[48:51], v[80:83], v[148:151], v[48:51]
    ds_read_b64_tr_b16 v[114:115], v236 offset:28672
    s_add_u32 s34, s34, 1024
    v_mfma_f32_16x16x32_bf16 v[20:23], v[84:87], v[144:147], v[20:23]
    ds_read_b64_tr_b16 v[116:117], v237 offset:24576
    v_mfma_f32_16x16x32_bf16 v[52:55], v[84:87], v[148:151], v[52:55]
    ds_read_b64_tr_b16 v[118:119], v237 offset:28672
    s_waitcnt lgkmcnt(12)
    v_mfma_f32_16x16x32_bf16 v[24:27], v[88:91], v[144:147], v[24:27]
    ds_read_b64_tr_b16 v[120:121], v238 offset:24576
    v_mfma_f32_16x16x32_bf16 v[56:59], v[88:91], v[148:151], v[56:59]
    ds_read_b64_tr_b16 v[122:123], v238 offset:28672
    v_mfma_f32_16x16x32_bf16 v[28:31], v[92:95], v[144:147], v[28:31]
    ds_read_b64_tr_b16 v[124:125], v239 offset:24576
    s_waitcnt vmcnt(12)
    v_mfma_f32_16x16x32_bf16 v[60:63], v[92:95], v[148:151], v[60:63]
    ds_read_b64_tr_b16 v[126:127], v239 offset:28672
    s_waitcnt lgkmcnt(12)
    v_mfma_f32_16x16x32_bf16 v[0:3], v[96:99], v[152:155], v[0:3]
    s_barrier
    ds_read_b64_tr_b16 v[64:65], v232 offset:32768
    v_mfma_f32_16x16x32_bf16 v[32:35], v[96:99], v[156:159], v[32:35]
    ds_read_b64_tr_b16 v[66:67], v232 offset:36864
    buffer_load_dwordx4 v[144:147], v241, s[20:23], s34 offen sc1
    v_mfma_f32_16x16x32_bf16 v[4:7], v[100:103], v[152:155], v[4:7]
    ds_read_b64_tr_b16 v[68:69], v233 offset:32768
    v_mfma_f32_16x16x32_bf16 v[36:39], v[100:103], v[156:159], v[36:39]
    ds_read_b64_tr_b16 v[70:71], v233 offset:36864
    s_waitcnt lgkmcnt(12)
    v_mfma_f32_16x16x32_bf16 v[8:11], v[104:107], v[152:155], v[8:11]
    ds_read_b64_tr_b16 v[72:73], v234 offset:32768
    v_mfma_f32_16x16x32_bf16 v[40:43], v[104:107], v[156:159], v[40:43]
    ds_read_b64_tr_b16 v[74:75], v234 offset:36864
    buffer_load_dwordx4 v[148:151], v242, s[20:23], s34 offen sc1
    v_mfma_f32_16x16x32_bf16 v[12:15], v[108:111], v[152:155], v[12:15]
    ds_read_b64_tr_b16 v[76:77], v235 offset:32768
    v_mfma_f32_16x16x32_bf16 v[44:47], v[108:111], v[156:159], v[44:47]
    ds_read_b64_tr_b16 v[78:79], v235 offset:36864
    s_waitcnt lgkmcnt(12)
    v_mfma_f32_16x16x32_bf16 v[16:19], v[112:115], v[152:155], v[16:19]
    ds_read_b64_tr_b16 v[80:81], v236 offset:32768
    v_mfma_f32_16x16x32_bf16 v[48:51], v[112:115], v[156:159], v[48:51]
    ds_read_b64_tr_b16 v[82:83], v236 offset:36864
    s_add_u32 s34, s34, 1024
    v_mfma_f32_16x16x32_bf16 v[20:23], v[116:119], v[152:155], v[20:23]
    ds_read_b64_tr_b16 v[84:85], v237 offset:32768
    v_mfma_f32_16x16x32_bf16 v[52:55], v[116:119], v[156:159], v[52:55]
    ds_read_b64_tr_b16 v[86:87], v237 offset:36864
    s_waitcnt lgkmcnt(12)
    v_mfma_f32_16x16x32_bf16 v[24:27], v[120:123], v[152:155], v[24:27]
    ds_read_b64_tr_b16 v[88:89], v238 offset:32768
    v_mfma_f32_16x16x32_bf16 v[56:59], v[120:123], v[156:159], v[56:59]
    ds_read_b64_tr_b16 v[90:91], v238 offset:36864
    v_mfma_f32_16x16x32_bf16 v[28:31], v[124:127], v[152:155], v[28:31]
    ds_read_b64_tr_b16 v[92:93], v239 offset:32768
    s_waitcnt vmcnt(12)
    v_mfma_f32_16x16x32_bf16 v[60:63], v[124:127], v[156:159], v[60:63]
    ds_read_b64_tr_b16 v[94:95], v239 offset:36864
    s_waitcnt lgkmcnt(12)
    v_mfma_f32_16x16x32_bf16 v[0:3], v[64:67], v[160:163], v[0:3]
    ds_read_b64_tr_b16 v[96:97], v232 offset:40960
    v_mfma_f32_16x16x32_bf16 v[32:35], v[64:67], v[164:167], v[32:35]
    ds_read_b64_tr_b16 v[98:99], v232 offset:45056
    buffer_load_dwordx4 v[152:155], v241, s[20:23], s34 offen sc1
    v_mfma_f32_16x16x32_bf16 v[4:7], v[68:71], v[160:163], v[4:7]
    ds_read_b64_tr_b16 v[100:101], v233 offset:40960
    v_mfma_f32_16x16x32_bf16 v[36:39], v[68:71], v[164:167], v[36:39]
    ds_read_b64_tr_b16 v[102:103], v233 offset:45056
    s_waitcnt lgkmcnt(12)
    v_mfma_f32_16x16x32_bf16 v[8:11], v[72:75], v[160:163], v[8:11]
    ds_read_b64_tr_b16 v[104:105], v234 offset:40960
    v_mfma_f32_16x16x32_bf16 v[40:43], v[72:75], v[164:167], v[40:43]
    ds_read_b64_tr_b16 v[106:107], v234 offset:45056
    buffer_load_dwordx4 v[156:159], v242, s[20:23], s34 offen sc1
    v_mfma_f32_16x16x32_bf16 v[12:15], v[76:79], v[160:163], v[12:15]
    ds_read_b64_tr_b16 v[108:109], v235 offset:40960
    v_mfma_f32_16x16x32_bf16 v[44:47], v[76:79], v[164:167], v[44:47]
    ds_read_b64_tr_b16 v[110:111], v235 offset:45056
    s_waitcnt lgkmcnt(12)
    v_mfma_f32_16x16x32_bf16 v[16:19], v[80:83], v[160:163], v[16:19]
    ds_read_b64_tr_b16 v[112:113], v236 offset:40960
    v_mfma_f32_16x16x32_bf16 v[48:51], v[80:83], v[164:167], v[48:51]
    ds_read_b64_tr_b16 v[114:115], v236 offset:45056
    s_add_u32 s34, s34, 1024
    v_mfma_f32_16x16x32_bf16 v[20:23], v[84:87], v[160:163], v[20:23]
    ds_read_b64_tr_b16 v[116:117], v237 offset:40960
    v_mfma_f32_16x16x32_bf16 v[52:55], v[84:87], v[164:167], v[52:55]
    ds_read_b64_tr_b16 v[118:119], v237 offset:45056
    s_waitcnt lgkmcnt(12)
    v_mfma_f32_16x16x32_bf16 v[24:27], v[88:91], v[160:163], v[24:27]
    ds_read_b64_tr_b16 v[120:121], v238 offset:40960
    v_mfma_f32_16x16x32_bf16 v[56:59], v[88:91], v[164:167], v[56:59]
    ds_read_b64_tr_b16 v[122:123], v238 offset:45056
    v_mfma_f32_16x16x32_bf16 v[28:31], v[92:95], v[160:163], v[28:31]
    ds_read_b64_tr_b16 v[124:125], v239 offset:40960
    s_waitcnt vmcnt(12)
    v_mfma_f32_16x16x32_bf16 v[60:63], v[92:95], v[164:167], v[60:63]
    ds_read_b64_tr_b16 v[126:127], v239 offset:45056
    s_waitcnt lgkmcnt(12)
    v_mfma_f32_16x16x32_bf16 v[0:3], v[96:99], v[168:171], v[0:3]
    s_barrier
    ds_read_b64_tr_b16 v[64:65], v232 offset:49152
    v_mfma_f32_16x16x32_bf16 v[32:35], v[96:99], v[172:175], v[32:35]
    ds_read_b64_tr_b16 v[66:67], v232 offset:53248
    buffer_load_dwordx4 v[160:163], v241, s[20:23], s34 offen sc1
    v_mfma_f32_16x16x32_bf16 v[4:7], v[100:103], v[168:171], v[4:7]
    ds_read_b64_tr_b16 v[68:69], v233 offset:49152
    v_mfma_f32_16x16x32_bf16 v[36:39], v[100:103], v[172:175], v[36:39]
    ds_read_b64_tr_b16 v[70:71], v233 offset:53248
    s_waitcnt lgkmcnt(12)
    v_mfma_f32_16x16x32_bf16 v[8:11], v[104:107], v[168:171], v[8:11]
    ds_read_b64_tr_b16 v[72:73], v234 offset:49152
    v_mfma_f32_16x16x32_bf16 v[40:43], v[104:107], v[172:175], v[40:43]
    ds_read_b64_tr_b16 v[74:75], v234 offset:53248
    buffer_load_dwordx4 v[164:167], v242, s[20:23], s34 offen sc1
    v_mfma_f32_16x16x32_bf16 v[12:15], v[108:111], v[168:171], v[12:15]
    ds_read_b64_tr_b16 v[76:77], v235 offset:49152
    v_mfma_f32_16x16x32_bf16 v[44:47], v[108:111], v[172:175], v[44:47]
    ds_read_b64_tr_b16 v[78:79], v235 offset:53248
    s_waitcnt lgkmcnt(12)
    v_mfma_f32_16x16x32_bf16 v[16:19], v[112:115], v[168:171], v[16:19]
    ds_read_b64_tr_b16 v[80:81], v236 offset:49152
    v_mfma_f32_16x16x32_bf16 v[48:51], v[112:115], v[172:175], v[48:51]
    ds_read_b64_tr_b16 v[82:83], v236 offset:53248
    s_add_u32 s34, s34, 1024
    v_mfma_f32_16x16x32_bf16 v[20:23], v[116:119], v[168:171], v[20:23]
    ds_read_b64_tr_b16 v[84:85], v237 offset:49152
    v_mfma_f32_16x16x32_bf16 v[52:55], v[116:119], v[172:175], v[52:55]
    ds_read_b64_tr_b16 v[86:87], v237 offset:53248
    s_waitcnt lgkmcnt(12)
    v_mfma_f32_16x16x32_bf16 v[24:27], v[120:123], v[168:171], v[24:27]
    ds_read_b64_tr_b16 v[88:89], v238 offset:49152
    v_mfma_f32_16x16x32_bf16 v[56:59], v[120:123], v[172:175], v[56:59]
    ds_read_b64_tr_b16 v[90:91], v238 offset:53248
    v_mfma_f32_16x16x32_bf16 v[28:31], v[124:127], v[168:171], v[28:31]
    ds_read_b64_tr_b16 v[92:93], v239 offset:49152
    s_waitcnt vmcnt(12)
    v_mfma_f32_16x16x32_bf16 v[60:63], v[124:127], v[172:175], v[60:63]
    ds_read_b64_tr_b16 v[94:95], v239 offset:53248
    s_waitcnt lgkmcnt(12)
    v_mfma_f32_16x16x32_bf16 v[0:3], v[64:67], v[176:179], v[0:3]
    ds_read_b64_tr_b16 v[96:97], v232 offset:57344
    v_mfma_f32_16x16x32_bf16 v[32:35], v[64:67], v[180:183], v[32:35]
    ds_read_b64_tr_b16 v[98:99], v232 offset:61440
    buffer_load_dwordx4 v[168:171], v241, s[20:23], s34 offen sc1
    v_mfma_f32_16x16x32_bf16 v[4:7], v[68:71], v[176:179], v[4:7]
    ds_read_b64_tr_b16 v[100:101], v233 offset:57344
    v_mfma_f32_16x16x32_bf16 v[36:39], v[68:71], v[180:183], v[36:39]
    ds_read_b64_tr_b16 v[102:103], v233 offset:61440
    s_waitcnt lgkmcnt(12)
    v_mfma_f32_16x16x32_bf16 v[8:11], v[72:75], v[176:179], v[8:11]
    ds_read_b64_tr_b16 v[104:105], v234 offset:57344
    v_mfma_f32_16x16x32_bf16 v[40:43], v[72:75], v[180:183], v[40:43]
    ds_read_b64_tr_b16 v[106:107], v234 offset:61440
    buffer_load_dwordx4 v[172:175], v242, s[20:23], s34 offen sc1
    v_mfma_f32_16x16x32_bf16 v[12:15], v[76:79], v[176:179], v[12:15]
    ds_read_b64_tr_b16 v[108:109], v235 offset:57344
    v_mfma_f32_16x16x32_bf16 v[44:47], v[76:79], v[180:183], v[44:47]
    ds_read_b64_tr_b16 v[110:111], v235 offset:61440
    s_waitcnt lgkmcnt(12)
    v_mfma_f32_16x16x32_bf16 v[16:19], v[80:83], v[176:179], v[16:19]
    ds_read_b64_tr_b16 v[112:113], v236 offset:57344
    v_mfma_f32_16x16x32_bf16 v[48:51], v[80:83], v[180:183], v[48:51]
    ds_read_b64_tr_b16 v[114:115], v236 offset:61440
    s_add_u32 s34, s34, 1024
    v_mfma_f32_16x16x32_bf16 v[20:23], v[84:87], v[176:179], v[20:23]
    ds_read_b64_tr_b16 v[116:117], v237 offset:57344
    v_mfma_f32_16x16x32_bf16 v[52:55], v[84:87], v[180:183], v[52:55]
    ds_read_b64_tr_b16 v[118:119], v237 offset:61440
    s_waitcnt lgkmcnt(12)
    v_mfma_f32_16x16x32_bf16 v[24:27], v[88:91], v[176:179], v[24:27]
    ds_read_b64_tr_b16 v[120:121], v238 offset:57344
    v_mfma_f32_16x16x32_bf16 v[56:59], v[88:91], v[180:183], v[56:59]
    ds_read_b64_tr_b16 v[122:123], v238 offset:61440
    v_mfma_f32_16x16x32_bf16 v[28:31], v[92:95], v[176:179], v[28:31]
    ds_read_b64_tr_b16 v[124:125], v239 offset:57344
    s_waitcnt vmcnt(12)
    v_mfma_f32_16x16x32_bf16 v[60:63], v[92:95], v[180:183], v[60:63]
    ds_read_b64_tr_b16 v[126:127], v239 offset:61440
    s_waitcnt lgkmcnt(12)
    v_mfma_f32_16x16x32_bf16 v[0:3], v[96:99], v[184:187], v[0:3]
    s_barrier
    v_xor_b32 v232, 0x10000, v232
    ds_read_b64_tr_b16 v[64:65], v232 offset:0
    v_mfma_f32_16x16x32_bf16 v[32:35], v[96:99], v[188:191], v[32:35]
    ds_read_b64_tr_b16 v[66:67], v232 offset:4096
    buffer_load_dwordx4 v[176:179], v241, s[20:23], s34 offen sc1
    v_mfma_f32_16x16x32_bf16 v[4:7], v[100:103], v[184:187], v[4:7]
    v_xor_b32 v233, 0x10000, v233
    ds_read_b64_tr_b16 v[68:69], v233 offset:0
    v_mfma_f32_16x16x32_bf16 v[36:39], v[100:103], v[188:191], v[36:39]
    ds_read_b64_tr_b16 v[70:71], v233 offset:4096
    s_waitcnt lgkmcnt(12)
    v_mfma_f32_16x16x32_bf16 v[8:11], v[104:107], v[184:187], v[8:11]
    v_xor_b32 v234, 0x10000, v234
    ds_read_b64_tr_b16 v[72:73], v234 offset:0
    v_mfma_f32_16x16x32_bf16 v[40:43], v[104:107], v[188:191], v[40:43]
    ds_read_b64_tr_b16 v[74:75], v234 offset:4096
    buffer_load_dwordx4 v[180:183], v242, s[20:23], s34 offen sc1
    v_mfma_f32_16x16x32_bf16 v[12:15], v[108:111], v[184:187], v[12:15]
    v_xor_b32 v235, 0x10000, v235
    ds_read_b64_tr_b16 v[76:77], v235 offset:0
    v_mfma_f32_16x16x32_bf16 v[44:47], v[108:111], v[188:191], v[44:47]
    ds_read_b64_tr_b16 v[78:79], v235 offset:4096
    s_waitcnt lgkmcnt(12)
    v_mfma_f32_16x16x32_bf16 v[16:19], v[112:115], v[184:187], v[16:19]
    v_xor_b32 v236, 0x10000, v236
    ds_read_b64_tr_b16 v[80:81], v236 offset:0
    v_mfma_f32_16x16x32_bf16 v[48:51], v[112:115], v[188:191], v[48:51]
    ds_read_b64_tr_b16 v[82:83], v236 offset:4096
    s_add_u32 s34, s34, 1024
    v_mfma_f32_16x16x32_bf16 v[20:23], v[116:119], v[184:187], v[20:23]
    v_xor_b32 v237, 0x10000, v237
    ds_read_b64_tr_b16 v[84:85], v237 offset:0
    v_mfma_f32_16x16x32_bf16 v[52:55], v[116:119], v[188:191], v[52:55]
    ds_read_b64_tr_b16 v[86:87], v237 offset:4096
    s_waitcnt lgkmcnt(12)
    v_mfma_f32_16x16x32_bf16 v[24:27], v[120:123], v[184:187], v[24:27]
    v_xor_b32 v238, 0x10000, v238
    ds_read_b64_tr_b16 v[88:89], v238 offset:0
    v_mfma_f32_16x16x32_bf16 v[56:59], v[120:123], v[188:191], v[56:59]
    ds_read_b64_tr_b16 v[90:91], v238 offset:4096
    s_sub_u32 s33, s33, 1
    v_mfma_f32_16x16x32_bf16 v[28:31], v[124:127], v[184:187], v[28:31]
    v_xor_b32 v239, 0x10000, v239
    ds_read_b64_tr_b16 v[92:93], v239 offset:0
    v_mfma_f32_16x16x32_bf16 v[60:63], v[124:127], v[188:191], v[60:63]
    ds_read_b64_tr_b16 v[94:95], v239 offset:4096
    s_waitcnt vmcnt(12) lgkmcnt(12)
    s_cmp_lg_u32 s33, 0
    s_cbranch_scc1 pb_loop
    v_lshlrev_b32 v243, 4, v240
    s_lshl_b32 s34, s2, 2
    s_add_u32 s34, s34, s24
    s_lshl_b32 s35, s34, 12
    s_add_u32 s35, s35, 1048576
    s_lshl_b32 s31, s24, 11
    s_add_u32 s31, s31, 131072
    v_add_u32 v244, s31, v243
    ds_read_b128 v[224:227], v244
    v_cvt_pk_bf16_f32 v32, v32, v33
    v_cvt_pk_bf16_f32 v33, v34, v35
    v_cvt_pk_bf16_f32 v34, v36, v37
    v_cvt_pk_bf16_f32 v35, v38, v39
    buffer_store_dwordx4 v[32:35], v243, s[80:83], s35 offen offset:0 sc1
    v_cvt_pk_bf16_f32 v40, v40, v41
    v_cvt_pk_bf16_f32 v41, v42, v43
    v_cvt_pk_bf16_f32 v42, v44, v45
    v_cvt_pk_bf16_f32 v43, v46, v47
    buffer_store_dwordx4 v[40:43], v243, s[80:83], s35 offen offset:1024 sc1
    v_cvt_pk_bf16_f32 v48, v48, v49
    v_cvt_pk_bf16_f32 v49, v50, v51
    v_cvt_pk_bf16_f32 v50, v52, v53
    v_cvt_pk_bf16_f32 v51, v54, v55
    buffer_store_dwordx4 v[48:51], v243, s[80:83], s35 offen offset:2048 sc1
    v_cvt_pk_bf16_f32 v56, v56, v57
    v_cvt_pk_bf16_f32 v57, v58, v59
    v_cvt_pk_bf16_f32 v58, v60, v61
    v_cvt_pk_bf16_f32 v59, v62, v63
    buffer_store_dwordx4 v[56:59], v243, s[80:83], s35 offen offset:3072 sc1
    s_lshl_b32 s31, s93, 7
    s_lshl_b32 s35, s95, 6
    s_add_u32 s31, s31, s35
    s_lshl_b32 s35, s24, 4
    s_add_u32 s31, s31, s35
    v_and_b32 v245, 15, v240
    v_add_u32 v245, s31, v245
    v_lshlrev_b32 v245, 2, v245
    buffer_load_dword v249, v245, s[80:83], 0 offen offset:0 sc1
    s_waitcnt lgkmcnt(0)
    v_mfma_f32_16x16x32_bf16 v[192:195], v[64:67], v[224:227], 0
    ds_read_b64_tr_b16 v[96:97], v232 offset:8192
    ds_read_b64_tr_b16 v[98:99], v232 offset:12288
    ds_read_b64_tr_b16 v[100:101], v233 offset:8192
    v_mfma_f32_16x16x32_bf16 v[196:199], v[68:71], v[224:227], 0
    ds_read_b64_tr_b16 v[102:103], v233 offset:12288
    ds_read_b64_tr_b16 v[104:105], v234 offset:8192
    v_mfma_f32_16x16x32_bf16 v[200:203], v[72:75], v[224:227], 0
    ds_read_b64_tr_b16 v[106:107], v234 offset:12288
    ds_read_b64_tr_b16 v[108:109], v235 offset:8192
    v_mfma_f32_16x16x32_bf16 v[204:207], v[76:79], v[224:227], 0
    ds_read_b64_tr_b16 v[110:111], v235 offset:12288
    ds_read_b64_tr_b16 v[112:113], v236 offset:8192
    v_mfma_f32_16x16x32_bf16 v[208:211], v[80:83], v[224:227], 0
    ds_read_b64_tr_b16 v[114:115], v236 offset:12288
    ds_read_b64_tr_b16 v[116:117], v237 offset:8192
    v_mfma_f32_16x16x32_bf16 v[212:215], v[84:87], v[224:227], 0
    ds_read_b64_tr_b16 v[118:119], v237 offset:12288
    ds_read_b64_tr_b16 v[120:121], v238 offset:8192
    v_mfma_f32_16x16x32_bf16 v[216:219], v[88:91], v[224:227], 0
    ds_read_b64_tr_b16 v[122:123], v238 offset:12288
    ds_read_b64_tr_b16 v[124:125], v239 offset:8192
    v_mfma_f32_16x16x32_bf16 v[220:223], v[92:95], v[224:227], 0
    ds_read_b64_tr_b16 v[126:127], v239 offset:12288
    ds_read_b128 v[228:231], v244 offset:1024
    s_barrier
    s_waitcnt lgkmcnt(0)
    v_mfma_f32_16x16x32_bf16 v[192:195], v[96:99], v[228:231], v[192:195]
    ds_read_b64_tr_b16 v[64:65], v232 offset:16384
    ds_read_b64_tr_b16 v[66:67], v232 offset:20480
    ds_read_b64_tr_b16 v[68:69], v233 offset:16384
    v_mfma_f32_16x16x32_bf16 v[196:199], v[100:103], v[228:231], v[196:199]
    ds_read_b64_tr_b16 v[70:71], v233 offset:20480
    ds_read_b64_tr_b16 v[72:73], v234 offset:16384
    v_mfma_f32_16x16x32_bf16 v[200:203], v[104:107], v[228:231], v[200:203]
    ds_read_b64_tr_b16 v[74:75], v234 offset:20480
    ds_read_b64_tr_b16 v[76:77], v235 offset:16384
    v_mfma_f32_16x16x32_bf16 v[204:207], v[108:111], v[228:231], v[204:207]
    ds_read_b64_tr_b16 v[78:79], v235 offset:20480
    ds_read_b64_tr_b16 v[80:81], v236 offset:16384
    v_mfma_f32_16x16x32_bf16 v[208:211], v[112:115], v[228:231], v[208:211]
    ds_read_b64_tr_b16 v[82:83], v236 offset:20480
    ds_read_b64_tr_b16 v[84:85], v237 offset:16384
    v_mfma_f32_16x16x32_bf16 v[212:215], v[116:119], v[228:231], v[212:215]
    ds_read_b64_tr_b16 v[86:87], v237 offset:20480
    ds_read_b64_tr_b16 v[88:89], v238 offset:16384
    v_mfma_f32_16x16x32_bf16 v[216:219], v[120:123], v[228:231], v[216:219]
    ds_read_b64_tr_b16 v[90:91], v238 offset:20480
    ds_read_b64_tr_b16 v[92:93], v239 offset:16384
    v_mfma_f32_16x16x32_bf16 v[220:223], v[124:127], v[228:231], v[220:223]
    ds_read_b64_tr_b16 v[94:95], v239 offset:20480
    ds_read_b128 v[224:227], v244 offset:8192
    s_waitcnt lgkmcnt(0)
    v_mfma_f32_16x16x32_bf16 v[192:195], v[64:67], v[224:227], v[192:195]
    ds_read_b64_tr_b16 v[96:97], v232 offset:24576
    ds_read_b64_tr_b16 v[98:99], v232 offset:28672
    ds_read_b64_tr_b16 v[100:101], v233 offset:24576
    v_mfma_f32_16x16x32_bf16 v[196:199], v[68:71], v[224:227], v[196:199]
    ds_read_b64_tr_b16 v[102:103], v233 offset:28672
    ds_read_b64_tr_b16 v[104:105], v234 offset:24576
    v_mfma_f32_16x16x32_bf16 v[200:203], v[72:75], v[224:227], v[200:203]
    ds_read_b64_tr_b16 v[106:107], v234 offset:28672
    ds_read_b64_tr_b16 v[108:109], v235 offset:24576
    v_mfma_f32_16x16x32_bf16 v[204:207], v[76:79], v[224:227], v[204:207]
    ds_read_b64_tr_b16 v[110:111], v235 offset:28672
    ds_read_b64_tr_b16 v[112:113], v236 offset:24576
    v_mfma_f32_16x16x32_bf16 v[208:211], v[80:83], v[224:227], v[208:211]
    ds_read_b64_tr_b16 v[114:115], v236 offset:28672
    ds_read_b64_tr_b16 v[116:117], v237 offset:24576
    v_mfma_f32_16x16x32_bf16 v[212:215], v[84:87], v[224:227], v[212:215]
    ds_read_b64_tr_b16 v[118:119], v237 offset:28672
    ds_read_b64_tr_b16 v[120:121], v238 offset:24576
    v_mfma_f32_16x16x32_bf16 v[216:219], v[88:91], v[224:227], v[216:219]
    ds_read_b64_tr_b16 v[122:123], v238 offset:28672
    ds_read_b64_tr_b16 v[124:125], v239 offset:24576
    v_mfma_f32_16x16x32_bf16 v[220:223], v[92:95], v[224:227], v[220:223]
    ds_read_b64_tr_b16 v[126:127], v239 offset:28672
    ds_read_b128 v[228:231], v244 offset:9216
    s_waitcnt lgkmcnt(0)
    v_mfma_f32_16x16x32_bf16 v[192:195], v[96:99], v[228:231], v[192:195]
    v_mfma_f32_16x16x32_bf16 v[196:199], v[100:103], v[228:231], v[196:199]
    v_mfma_f32_16x16x32_bf16 v[200:203], v[104:107], v[228:231], v[200:203]
    v_mfma_f32_16x16x32_bf16 v[204:207], v[108:111], v[228:231], v[204:207]
    v_mfma_f32_16x16x32_bf16 v[208:211], v[112:115], v[228:231], v[208:211]
    v_mfma_f32_16x16x32_bf16 v[212:215], v[116:119], v[228:231], v[212:215]
    v_mfma_f32_16x16x32_bf16 v[216:219], v[120:123], v[228:231], v[216:219]
    v_mfma_f32_16x16x32_bf16 v[220:223], v[124:127], v[228:231], v[220:223]
    s_lshl_b32 s35, s34, 7
    s_add_u32 s35, s35, 131072
    v_mov_b32 v245, s35
    v_mov_b32 v246, s92
    s_waitcnt vmcnt(0)
    buffer_store_dword v246, v245, s[80:83], 0 offen sc1
    s_xor_b32 s34, s2, 1
    s_lshl_b32 s34, s34, 2
    s_add_u32 s34, s34, s24
    s_lshl_b32 s35, s34, 7
    s_add_u32 s35, s35, 131072
    v_mov_b32 v248, s35
    v_sub_f32 v192, v192, v0
    v_sub_f32 v193, v193, v1
    v_sub_f32 v194, v194, v2
    v_sub_f32 v195, v195, v3
    v_sub_f32 v196, v196, v4
    v_sub_f32 v197, v197, v5
    v_sub_f32 v198, v198, v6
    v_sub_f32 v199, v199, v7
    v_sub_f32 v200, v200, v8
    v_sub_f32 v201, v201, v9
    v_sub_f32 v202, v202, v10
    v_sub_f32 v203, v203, v11
    v_sub_f32 v204, v204, v12
    v_sub_f32 v205, v205, v13
    v_sub_f32 v206, v206, v14
    v_sub_f32 v207, v207, v15
    v_sub_f32 v208, v208, v16
    v_sub_f32 v209, v209, v17
    v_sub_f32 v210, v210, v18
    v_sub_f32 v211, v211, v19
    v_sub_f32 v212, v212, v20
    v_sub_f32 v213, v213, v21
    v_sub_f32 v214, v214, v22
    v_sub_f32 v215, v215, v23
    v_sub_f32 v216, v216, v24
    v_sub_f32 v217, v217, v25
    v_sub_f32 v218, v218, v26
    v_sub_f32 v219, v219, v27
    v_sub_f32 v220, v220, v28
    v_sub_f32 v221, v221, v29
    v_sub_f32 v222, v222, v30
    v_sub_f32 v223, v223, v31
    v_fmac_f32 v0, v249, v192
    v_fmac_f32 v1, v249, v193
    v_fmac_f32 v2, v249, v194
    v_fmac_f32 v3, v249, v195
    v_fmac_f32 v4, v249, v196
    v_fmac_f32 v5, v249, v197
    v_fmac_f32 v6, v249, v198
    v_fmac_f32 v7, v249, v199
    v_fmac_f32 v8, v249, v200
    v_fmac_f32 v9, v249, v201
    v_fmac_f32 v10, v249, v202
    v_fmac_f32 v11, v249, v203
    v_fmac_f32 v12, v249, v204
    v_fmac_f32 v13, v249, v205
    v_fmac_f32 v14, v249, v206
    v_fmac_f32 v15, v249, v207
    v_fmac_f32 v16, v249, v208
    v_fmac_f32 v17, v249, v209
    v_fmac_f32 v18, v249, v210
    v_fmac_f32 v19, v249, v211
    v_fmac_f32 v20, v249, v212
    v_fmac_f32 v21, v249, v213
    v_fmac_f32 v22, v249, v214
    v_fmac_f32 v23, v249, v215
    v_fmac_f32 v24, v249, v216
    v_fmac_f32 v25, v249, v217
    v_fmac_f32 v26, v249, v218
    v_fmac_f32 v27, v249, v219
    v_fmac_f32 v28, v249, v220
    v_fmac_f32 v29, v249, v221
    v_fmac_f32 v30, v249, v222
    v_fmac_f32 v31, v249, v223
    v_sub_f32 v249, 1.0, v249
    s_mov_b32 s57, 65536
pb_xpoll:
    buffer_load_dword v245, v248, s[80:83], 0 offen sc1
    s_sub_u32 s57, s57, 1
    s_waitcnt vmcnt(0)
    v_cmp_ne_u32 vcc, s92, v245
    s_cmp_eq_u32 s57, 0
    s_cbranch_scc1 pb_xpoll_done
    s_and_b32 s58, vcc_lo, 0x1
    s_cbranch_scc1 pb_xpoll
pb_xpoll_done:
    s_lshl_b32 s35, s34, 12
    s_add_u32 s35, s35, 1048576
    buffer_load_dwordx4 v[64:67], v243, s[80:83], s35 offen offset:0 sc1
    buffer_load_dwordx4 v[68:71], v243, s[80:83], s35 offen offset:1024 sc1
    buffer_load_dwordx4 v[72:75], v243, s[80:83], s35 offen offset:2048 sc1
    buffer_load_dwordx4 v[76:79], v243, s[80:83], s35 offen offset:3072 sc1
    s_mov_b32 s84, s70
    s_mov_b32 s85, s71
    s_mov_b32 s86, 4194304
    s_mov_b32 s87, 0x20000
    v_and_b32 v245, 15, v240
    v_lshrrev_b32 v246, 4, v240
    v_lshlrev_b32 v245, 16, v245
    v_and_b32 v247, 1, v246
    v_lshlrev_b32 v247, 5, v247
    v_lshrrev_b32 v246, 1, v246
    v_lshl_add_u32 v247, v246, 4, v247
    v_add_u32 v245, v245, v247
    s_lshl_b32 s34, s93, 1
    s_add_u32 s34, s34, s95
    s_lshl_b32 s34, s34, 11
    s_lshl_b32 s35, s24, 20
    s_add_u32 s34, s34, s35
    s_lshl_b32 s35, s94, 8
    s_add_u32 s34, s34, s35
    s_mov_b32 s36, 0xffff0000
    s_waitcnt vmcnt(3)
    v_lshlrev_b32 v100, 16, v64
    v_and_b32 v101, s36, v64
    v_fmac_f32 v0, v249, v100
    v_fmac_f32 v1, v249, v101
    v_lshlrev_b32 v100, 16, v65
    v_and_b32 v101, s36, v65
    v_fmac_f32 v2, v249, v100
    v_fmac_f32 v3, v249, v101
    v_cvt_pk_bf16_f32 v128, v0, v1
    v_cvt_pk_bf16_f32 v129, v2, v3
    v_lshlrev_b32 v100, 16, v66
    v_and_b32 v101, s36, v66
    v_fmac_f32 v4, v249, v100
    v_fmac_f32 v5, v249, v101
    v_lshlrev_b32 v100, 16, v67
    v_and_b32 v101, s36, v67
    v_fmac_f32 v6, v249, v100
    v_fmac_f32 v7, v249, v101
    v_cvt_pk_bf16_f32 v130, v4, v5
    v_cvt_pk_bf16_f32 v131, v6, v7
    s_nop 1
    v_permlane16_swap_b32 v128, v130
    v_permlane16_swap_b32 v129, v131
    buffer_store_dwordx4 v[128:131], v245, s[84:87], s34 offen offset:0 nt
    s_waitcnt vmcnt(3)
    v_lshlrev_b32 v100, 16, v68
    v_and_b32 v101, s36, v68
    v_fmac_f32 v8, v249, v100
    v_fmac_f32 v9, v249, v101
    v_lshlrev_b32 v100, 16, v69
    v_and_b32 v101, s36, v69
    v_fmac_f32 v10, v249, v100
    v_fmac_f32 v11, v249, v101
    v_cvt_pk_bf16_f32 v132, v8, v9
    v_cvt_pk_bf16_f32 v133, v10, v11
    v_lshlrev_b32 v100, 16, v70
    v_and_b32 v101, s36, v70
    v_fmac_f32 v12, v249, v100
    v_fmac_f32 v13, v249, v101
    v_lshlrev_b32 v100, 16, v71
    v_and_b32 v101, s36, v71
    v_fmac_f32 v14, v249, v100
    v_fmac_f32 v15, v249, v101
    v_cvt_pk_bf16_f32 v134, v12, v13
    v_cvt_pk_bf16_f32 v135, v14, v15
    s_nop 1
    v_permlane16_swap_b32 v132, v134
    v_permlane16_swap_b32 v133, v135
    buffer_store_dwordx4 v[132:135], v245, s[84:87], s34 offen offset:64 nt
    s_waitcnt vmcnt(3)
    v_lshlrev_b32 v100, 16, v72
    v_and_b32 v101, s36, v72
    v_fmac_f32 v16, v249, v100
    v_fmac_f32 v17, v249, v101
    v_lshlrev_b32 v100, 16, v73
    v_and_b32 v101, s36, v73
    v_fmac_f32 v18, v249, v100
    v_fmac_f32 v19, v249, v101
    v_cvt_pk_bf16_f32 v136, v16, v17
    v_cvt_pk_bf16_f32 v137, v18, v19
    v_lshlrev_b32 v100, 16, v74
    v_and_b32 v101, s36, v74
    v_fmac_f32 v20, v249, v100
    v_fmac_f32 v21, v249, v101
    v_lshlrev_b32 v100, 16, v75
    v_and_b32 v101, s36, v75
    v_fmac_f32 v22, v249, v100
    v_fmac_f32 v23, v249, v101
    v_cvt_pk_bf16_f32 v138, v20, v21
    v_cvt_pk_bf16_f32 v139, v22, v23
    s_nop 1
    v_permlane16_swap_b32 v136, v138
    v_permlane16_swap_b32 v137, v139
    buffer_store_dwordx4 v[136:139], v245, s[84:87], s34 offen offset:128 nt
    s_waitcnt vmcnt(3)
    v_lshlrev_b32 v100, 16, v76
    v_and_b32 v101, s36, v76
    v_fmac_f32 v24, v249, v100
    v_fmac_f32 v25, v249, v101
    v_lshlrev_b32 v100, 16, v77
    v_and_b32 v101, s36, v77
    v_fmac_f32 v26, v249, v100
    v_fmac_f32 v27, v249, v101
    v_cvt_pk_bf16_f32 v140, v24, v25
    v_cvt_pk_bf16_f32 v141, v26, v27
    v_lshlrev_b32 v100, 16, v78
    v_and_b32 v101, s36, v78
    v_fmac_f32 v28, v249, v100
    v_fmac_f32 v29, v249, v101
    v_lshlrev_b32 v100, 16, v79
    v_and_b32 v101, s36, v79
    v_fmac_f32 v30, v249, v100
    v_fmac_f32 v31, v249, v101
    v_cvt_pk_bf16_f32 v142, v28, v29
    v_cvt_pk_bf16_f32 v143, v30, v31
    s_nop 1
    v_permlane16_swap_b32 v140, v142
    v_permlane16_swap_b32 v141, v143
    buffer_store_dwordx4 v[140:143], v245, s[84:87], s34 offen offset:192 nt
    s_endpgm
k_fft:
    v_mov_b32 v255, v240
    s_waitcnt lgkmcnt(0)
    s_mov_b32 s12, s4
    s_mov_b32 s13, s5
    s_mov_b32 s14, 4194304
    s_mov_b32 s15, 0x20000
    s_mov_b32 s88, s8
    s_mov_b32 s89, s9
    s_mov_b32 s90, 256
    s_mov_b32 s91, 0x20000
    s_sub_u32 s27, s26, 28
    s_lshl_b32 s27, s27, 3
    s_add_u32 s27, s27, s25
    s_mov_b32 s28, 2
    s_lshl_b32 s29, s27, 7
    s_add_u32 s96, s29, 8192
    v_lshlrev_b32 v224, 4, v255
    s_lshl_b32 s29, s24, 2
    s_mul_i32 s30, s29, 2064
    s_lshl_b32 s31, s29, 6
    s_add_u32 s31, s31, s27
    s_lshl_b32 s31, s31, 11
    s_add_u32 m0, s30, 0
    s_add_u32 s32, s31, 0
    buffer_load_dwordx4 v224, s[12:15], s32 offen  lds
    buffer_load_dwordx4 v224, s[12:15], s32 offen offset:1024  lds
    s_add_u32 m0, s30, 2064
    s_add_u32 s32, s31, 131072
    buffer_load_dwordx4 v224, s[12:15], s32 offen  lds
    buffer_load_dwordx4 v224, s[12:15], s32 offen offset:1024  lds
    s_add_u32 m0, s30, 4128
    s_add_u32 s32, s31, 262144
    buffer_load_dwordx4 v224, s[12:15], s32 offen  lds
    buffer_load_dwordx4 v224, s[12:15], s32 offen offset:1024  lds
    s_add_u32 m0, s30, 6192
    s_add_u32 s32, s31, 393216
    buffer_load_dwordx4 v224, s[12:15], s32 offen  lds
    buffer_load_dwordx4 v224, s[12:15], s32 offen offset:1024  lds
    s_mov_b32 s16, s68
    s_mov_b32 s17, s69
    s_mov_b32 s18, 2048
    s_mov_b32 s19, 0x20000
    s_add_u32 s76, s10, 16777216
    s_addc_u32 s77, s11, 0
    s_mov_b32 s78, 8388608
    s_mov_b32 s79, 0x20000
    s_add_u32 s36, s10, 25165824
    s_addc_u32 s37, s11, 0
    s_mov_b32 s38, 8192
    s_mov_b32 s39, 0x20000
    s_cmp_lg_u32 s24, 0
    s_cbranch_scc1 fft_t1
    s_mov_b32 m0, 134144
    s_nop 0
    buffer_load_dwordx4 v224, s[16:19], 0 offen lds
    buffer_load_dwordx4 v224, s[16:19], 0 offen offset:1024 lds
fft_t1:
    v_lshlrev_b32 v225, 5, v255
    s_cmp_eq_u32 s24, 1
    s_cselect_b32 s29, 0xbf803f80, 0
    s_mov_b32 s30, 138272
    s_cselect_b32 s30, 136208, s30
    v_mov_b32 v228, s29
    v_mov_b32 v229, s29
    v_mov_b32 v230, s29
    v_mov_b32 v231, s29
    v_add_u32 v225, s30, v225
    s_sub_u32 s31, s24, 1
    s_cmp_gt_u32 s31, 1
    s_cbranch_scc1 fft_t2
    ds_write_b128 v225, v[228:231]
    ds_write_b128 v225, v[228:231] offset:16
fft_t2:
    s_cmp_lg_u32 s24, 3
    s_cbranch_scc1 fft_t3
    v_and_b32 v225, 15, v255
    v_lshlrev_b32 v225, 2, v225
    v_add_u32 v225, 104448, v225
    v_mov_b32 v226, 0
    ds_write_b32 v225, v226
fft_t3:
    s_cmp_lg_u32 s24, 4
    s_cbranch_scc1 fft_t4
    v_lshlrev_b32 v225, 2, v255
    v_add_u32 v226, 140336, v225
    v_mov_b32 v227, 0
    ds_write_b32 v226, v227
    ds_write_b32 v226, v227 offset:256
    v_and_b32 v225, 28, v225
    v_add_u32 v225, 152576, v225
    ds_write_b32 v225, v227
fft_t4:
    v_and_b32 v232, 31, v255
    v_lshrrev_b32 v233, 5, v255
    s_lshr_b32 s29, s24, 1
    s_and_b32 s30, s24, 1
    s_cmp_lt_u32 s29, 2
    s_cselect_b32 s31, 31, 15
    s_cselect_b32 s32, 8, 4
    s_cselect_b32 s33, 0, 4
    v_and_b32 v100, s31, v255
    v_cvt_f32_u32 v102, v100
    v_mul_f32 v102, 0x3d000000, v102
    v_mul_u32_u24 v101, s32, v233
    s_lshl_b32 s34, s30, 4
    v_add_u32 v101, s34, v101
    v_cvt_f32_u32 v101, v101
    v_mul_f32 v101, v101, v102
    v_bfe_u32 v100, v255, 4, 1
    s_cmp_lt_u32 s29, 2
    s_cselect_b32 s34, 0, 1
    v_mul_u32_u24 v100, s34, v100
    s_cmp_eq_u32 s29, 1
    s_cselect_b32 s35, 1, 0
    s_cmp_eq_u32 s29, 3
    s_cselect_b32 s35, 3, s35
    v_add_u32 v100, s35, v100
    v_cvt_f32_u32 v100, v100
    v_mov_b32 v103, 0x3e800000
    v_fmac_f32 v101, v100, v103
    v_cvt_f32_u32 v100, s33
    v_fma_f32 v104, v100, v102, v101
    v_mov_b32 v110, v101
    v_add_f32 v111, v110, v102
    v_add_f32 v112, v111, v102
    v_add_f32 v113, v112, v102
    v_fma_f32 v114, v102, 4.0, v104
    v_add_f32 v115, v114, v102
    v_add_f32 v116, v115, v102
    v_add_f32 v117, v116, v102
    v_cos_f32 v110, v110
    v_cos_f32 v111, v111
    v_cos_f32 v112, v112
    v_cos_f32 v113, v113
    v_cos_f32 v114, v114
    v_cos_f32 v115, v115
    v_cos_f32 v116, v116
    v_cos_f32 v117, v117
    s_nop 0
    v_cvt_pk_bf16_f32 v120, v110, v111
    v_cvt_pk_bf16_f32 v121, v112, v113
    v_cvt_pk_bf16_f32 v122, v114, v115
    v_cvt_pk_bf16_f32 v123, v116, v117
    s_lshl_b32 s34, s24, 10
    s_add_u32 s34, s34, 66560
    v_lshl_add_u32 v100, v255, 4, s34
    ds_write_b128 v100, v[120:123]
    v_cvt_f32_u32 v234, v232
    v_mul_f32 v234, 0x3a800000, v234
    v_cvt_f32_u32 v235, v233
    v_mul_f32 v235, 4.0, v235
    v_mul_f32 v235, v235, v234
    v_mov_b32 v48, 0.0
    v_fma_f32 v48, v48, v234, v235
    v_mov_b32 v49, 1.0
    v_fma_f32 v49, v49, v234, v235
    v_mov_b32 v50, 2.0
    v_fma_f32 v50, v50, v234, v235
    v_mov_b32 v51, 3.0
    v_fma_f32 v51, v51, v234, v235
    v_mov_b32 v52, 8.0
    v_fma_f32 v52, v52, v234, v235
    v_mov_b32 v53, 9.0
    v_fma_f32 v53, v53, v234, v235
    v_mov_b32 v54, 10.0
    v_fma_f32 v54, v54, v234, v235
    v_mov_b32 v55, 11.0
    v_fma_f32 v55, v55, v234, v235
    v_mov_b32 v56, 16.0
    v_fma_f32 v56, v56, v234, v235
    v_mov_b32 v57, 17.0
    v_fma_f32 v57, v57, v234, v235
    v_mov_b32 v58, 18.0
    v_fma_f32 v58, v58, v234, v235
    v_mov_b32 v59, 19.0
    v_fma_f32 v59, v59, v234, v235
    v_mov_b32 v60, 24.0
    v_fma_f32 v60, v60, v234, v235
    v_mov_b32 v61, 25.0
    v_fma_f32 v61, v61, v234, v235
    v_mov_b32 v62, 26.0
    v_fma_f32 v62, v62, v234, v235
    v_mov_b32 v63, 27.0
    v_fma_f32 v63, v63, v234, v235
    v_cos_f32 v32, v48
    v_cos_f32 v33, v49
    v_cos_f32 v34, v50
    v_cos_f32 v35, v51
    v_cos_f32 v36, v52
    v_cos_f32 v37, v53
    v_cos_f32 v38, v54
    v_cos_f32 v39, v55
    v_cos_f32 v40, v56
    v_cos_f32 v41, v57
    v_cos_f32 v42, v58
    v_cos_f32 v43, v59
    v_cos_f32 v44, v60
    v_cos_f32 v45, v61
    v_cos_f32 v46, v62
    v_cos_f32 v47, v63
    v_sin_f32 v48, v48
    v_sin_f32 v49, v49
    v_sin_f32 v50, v50
    v_sin_f32 v51, v51
    v_sin_f32 v52, v52
    v_sin_f32 v53, v53
    v_sin_f32 v54, v54
    v_sin_f32 v55, v55
    v_sin_f32 v56, v56
    v_sin_f32 v57, v57
    v_sin_f32 v58, v58
    v_sin_f32 v59, v59
    v_sin_f32 v60, v60
    v_sin_f32 v61, v61
    v_sin_f32 v62, v62
    v_sin_f32 v63, v63
    v_and_b32 v100, 7, v255
    v_mul_u32_u24 v100, 66, v100
    v_bfe_u32 v101, v255, 3, 2
    v_add_u32 v100, v100, v101
    v_lshl_add_u32 v100, v233, 4, v100
    s_lshr_b32 s29, s24, 1
    s_and_b32 s30, s24, 1
    s_lshl_b32 s30, s30, 3
    s_add_u32 s30, s30, 66560
    v_add_u32 v101, 0, v100
    v_bfe_u32 v102, v101, 2, 2
    v_xor_b32 v102, s29, v102
    v_lshlrev_b32 v102, 4, v102
    v_lshl_add_u32 v102, v101, 6, v102
    v_add_u32 v248, s30, v102
    v_add_u32 v101, 4, v100
    v_bfe_u32 v102, v101, 2, 2
    v_xor_b32 v102, s29, v102
    v_lshlrev_b32 v102, 4, v102
    v_lshl_add_u32 v102, v101, 6, v102
    v_add_u32 v249, s30, v102
    v_add_u32 v101, 8, v100
    v_bfe_u32 v102, v101, 2, 2
    v_xor_b32 v102, s29, v102
    v_lshlrev_b32 v102, 4, v102
    v_lshl_add_u32 v102, v101, 6, v102
    v_add_u32 v250, s30, v102
    v_add_u32 v101, 12, v100
    v_bfe_u32 v102, v101, 2, 2
    v_xor_b32 v102, s29, v102
    v_lshlrev_b32 v102, 4, v102
    v_lshl_add_u32 v102, v101, 6, v102
    v_add_u32 v251, s30, v102
    v_bfe_u32 v100, v255, 2, 2
    v_lshl_add_u32 v100, v233, 3, v100
    v_lshlrev_b32 v100, 6, v100
    v_bfe_u32 v101, v255, 4, 1
    v_lshl_add_u32 v100, v101, 5, v100
    v_and_b32 v101, 3, v255
    v_lshl_add_u32 v100, v101, 3, v100
    s_mul_i32 s29, s24, 8256
    v_add_u32 v252, s29, v100
    s_waitcnt lgkmcnt(0)
    s_barrier
    v_lshlrev_b32 v100, 4, v255
    v_add_u32 v100, 66560, v100
    ds_read_b128 v[0:3], v100 offset:0
    ds_read_b128 v[4:7], v100 offset:1024
    ds_read_b128 v[8:11], v100 offset:2048
    ds_read_b128 v[12:15], v100 offset:3072
    ds_read_b128 v[16:19], v100 offset:4096
    ds_read_b128 v[20:23], v100 offset:5120
    ds_read_b128 v[24:27], v100 offset:6144
    ds_read_b128 v[28:31], v100 offset:7168
    s_waitcnt vmcnt(0)
    s_mov_b32 s40, 1
    s_lshl_b32 s41, s24, 2
    s_add_u32 s41, s41, 152576
    v_mov_b32 v230, s41
    v_mov_b32 v231, s40
    ds_write_b32 v230, v231
    s_mov_b32 s34, 140336
    s_mov_b32 s35, 140848
fft_unit:
    s_cmp_ge_u32 s24, 4
    s_cbranch_scc1 fft_nocc
    v_and_b32 v100, 31, v255
    v_lshrrev_b32 v101, 5, v255
    v_cvt_f32_u32 v102, v100
    v_mul_f32 v103, 0x3d000000, v102
    v_mul_f32 v102, 0x3a000000, v102
    s_and_b32 s29, s24, 1
    s_lshl_b32 s29, s29, 4
    v_lshlrev_b32 v101, 3, v101
    v_add_u32 v101, s29, v101
    v_cvt_f32_u32 v101, v101
    v_mul_f32 v101, v101, v103
    v_cvt_f32_u32 v104, s27
    v_fmac_f32 v101, v104, v102
    s_cmp_ge_u32 s24, 2
    s_cselect_b32 s29, 0xbe800000, 0
    v_add_f32 v101, s29, v101
    v_mov_b32 v110, v101
    v_add_f32 v111, v110, v103
    v_add_f32 v112, v111, v103
    v_add_f32 v113, v112, v103
    v_add_f32 v114, v113, v103
    v_add_f32 v115, v114, v103
    v_add_f32 v116, v115, v103
    v_add_f32 v117, v116, v103
    v_cos_f32 v110, v110
    v_cos_f32 v111, v111
    v_cos_f32 v112, v112
    v_cos_f32 v113, v113
    v_cos_f32 v114, v114
    v_cos_f32 v115, v115
    v_cos_f32 v116, v116
    v_cos_f32 v117, v117
    s_nop 0
    v_cvt_pk_bf16_f32 v120, v110, v111
    v_cvt_pk_bf16_f32 v121, v112, v113
    v_cvt_pk_bf16_f32 v122, v114, v115
    v_cvt_pk_bf16_f32 v123, v116, v117
    s_lshl_b32 s29, s24, 10
    s_add_u32 s29, s29, s35
    v_lshl_add_u32 v100, v255, 4, s29
    ds_write_b128 v100, v[120:123]
fft_nocc:
    s_cmp_ge_u32 s24, 4
    s_cbranch_scc1 fft_noaux
    v_and_b32 v100, 7, v255
    v_lshlrev_b32 v100, 2, v100
    v_add_u32 v100, 152576, v100
fft_mkpoll:
    ds_read_b32 v101, v100
    s_waitcnt lgkmcnt(0)
    v_cmp_gt_u32 vcc, s40, v101
    s_nop 3
    s_cmp_lg_u32 vcc_lo, 0
    s_cbranch_scc1 fft_mkpoll
    v_and_b32 v100, 31, v255
    v_lshrrev_b32 v101, 5, v255
    s_lshl_b32 s29, s24, 9
    v_lshl_add_u32 v102, v101, 4, s29
    v_mul_u32_u24 v103, 2064, v100
    v_add_u32 v103, v103, v102
    v_mov_b32 v104, 138272
    v_mov_b32 v105, 136208
    v_cmp_eq_u32 vcc, 1, v100
    s_nop 1
    v_cndmask_b32 v104, v104, v105, vcc
    v_mov_b32 v105, 134144
    v_cmp_eq_u32 vcc, 0, v100
    s_nop 1
    v_cndmask_b32 v104, v104, v105, vcc
    v_add_u32 v104, v104, v102
    ds_read_b128 v[128:131], v104 offset:0
    ds_read_b128 v[132:135], v103 offset:0
    ds_read_b128 v[136:139], v104 offset:32
    ds_read_b128 v[140:143], v103 offset:32
    ds_read_b128 v[144:147], v104 offset:64
    ds_read_b128 v[148:151], v103 offset:64
    ds_read_b128 v[152:155], v104 offset:96
    ds_read_b128 v[156:159], v103 offset:96
    ds_read_b128 v[160:163], v104 offset:128
    ds_read_b128 v[164:167], v103 offset:128
    ds_read_b128 v[168:171], v104 offset:160
    ds_read_b128 v[172:175], v103 offset:160
    ds_read_b128 v[176:179], v104 offset:192
    ds_read_b128 v[180:183], v103 offset:192
    ds_read_b128 v[184:187], v104 offset:224
    ds_read_b128 v[188:191], v103 offset:224
    s_waitcnt lgkmcnt(14)
    v_mfma_f32_32x32x16_bf16 v[64:79], v[128:131], v[132:135], 0
    s_waitcnt lgkmcnt(12)
    v_mfma_f32_32x32x16_bf16 v[64:79], v[136:139], v[140:143], v[64:79]
    s_waitcnt lgkmcnt(10)
    v_mfma_f32_32x32x16_bf16 v[64:79], v[144:147], v[148:151], v[64:79]
    s_waitcnt lgkmcnt(8)
    v_mfma_f32_32x32x16_bf16 v[64:79], v[152:155], v[156:159], v[64:79]
    s_waitcnt lgkmcnt(6)
    v_mfma_f32_32x32x16_bf16 v[64:79], v[160:163], v[164:167], v[64:79]
    s_waitcnt lgkmcnt(4)
    v_mfma_f32_32x32x16_bf16 v[64:79], v[168:171], v[172:175], v[64:79]
    s_waitcnt lgkmcnt(2)
    v_mfma_f32_32x32x16_bf16 v[64:79], v[176:179], v[180:183], v[64:79]
    s_waitcnt lgkmcnt(0)
    v_mfma_f32_32x32x16_bf16 v[64:79], v[184:187], v[188:191], v[64:79]
    ds_read_b128 v[128:131], v104 offset:256
    ds_read_b128 v[132:135], v103 offset:256
    ds_read_b128 v[136:139], v104 offset:288
    ds_read_b128 v[140:143], v103 offset:288
    ds_read_b128 v[144:147], v104 offset:320
    ds_read_b128 v[148:151], v103 offset:320
    ds_read_b128 v[152:155], v104 offset:352
    ds_read_b128 v[156:159], v103 offset:352
    ds_read_b128 v[160:163], v104 offset:384
    ds_read_b128 v[164:167], v103 offset:384
    ds_read_b128 v[168:171], v104 offset:416
    ds_read_b128 v[172:175], v103 offset:416
    ds_read_b128 v[176:179], v104 offset:448
    ds_read_b128 v[180:183], v103 offset:448
    ds_read_b128 v[184:187], v104 offset:480
    ds_read_b128 v[188:191], v103 offset:480
    s_waitcnt lgkmcnt(14)
    v_mfma_f32_32x32x16_bf16 v[64:79], v[128:131], v[132:135], v[64:79]
    s_waitcnt lgkmcnt(12)
    v_mfma_f32_32x32x16_bf16 v[64:79], v[136:139], v[140:143], v[64:79]
    s_waitcnt lgkmcnt(10)
    v_mfma_f32_32x32x16_bf16 v[64:79], v[144:147], v[148:151], v[64:79]
    s_waitcnt lgkmcnt(8)
    v_mfma_f32_32x32x16_bf16 v[64:79], v[152:155], v[156:159], v[64:79]
    s_waitcnt lgkmcnt(6)
    v_mfma_f32_32x32x16_bf16 v[64:79], v[160:163], v[164:167], v[64:79]
    s_waitcnt lgkmcnt(4)
    v_mfma_f32_32x32x16_bf16 v[64:79], v[168:171], v[172:175], v[64:79]
    s_waitcnt lgkmcnt(2)
    v_mfma_f32_32x32x16_bf16 v[64:79], v[176:179], v[180:183], v[64:79]
    s_waitcnt lgkmcnt(0)
    v_mfma_f32_32x32x16_bf16 v[64:79], v[184:187], v[188:191], v[64:79]
    v_lshlrev_b32 v100, 2, v100
    v_add_u32 v100, s34, v100
    s_nop 7
    s_nop 1
    s_mov_b32 exec_hi, 0
    ds_add_f32 v100, v64
    ds_add_f32 v100, v65 offset:128
    s_mov_b32 exec_hi, -1
fft_noaux:
    s_waitcnt vmcnt(16) lgkmcnt(0)
    ds_read_b64_tr_b16 v[128:129], v252 offset:0
    ds_read_b64_tr_b16 v[130:131], v252 offset:256
    ds_read_b64_tr_b16 v[132:133], v252 offset:1024
    ds_read_b64_tr_b16 v[134:135], v252 offset:1280
    ds_read_b64_tr_b16 v[136:137], v252 offset:2064
    ds_read_b64_tr_b16 v[138:139], v252 offset:2320
    ds_read_b64_tr_b16 v[140:141], v252 offset:3088
    ds_read_b64_tr_b16 v[142:143], v252 offset:3344
    s_waitcnt lgkmcnt(4)
    v_mfma_f32_32x32x16_bf16 v[144:159], v[128:131], v[0:3], 0
    v_mfma_f32_32x32x16_bf16 v[160:175], v[128:131], v[8:11], 0
    v_mfma_f32_32x32x16_bf16 v[144:159], v[132:135], v[4:7], v[144:159]
    v_mfma_f32_32x32x16_bf16 v[160:175], v[132:135], v[12:15], v[160:175]
    ds_read_b64_tr_b16 v[128:129], v252 offset:4128
    ds_read_b64_tr_b16 v[130:131], v252 offset:4384
    ds_read_b64_tr_b16 v[132:133], v252 offset:5152
    ds_read_b64_tr_b16 v[134:135], v252 offset:5408
    s_nop 7
    s_waitcnt lgkmcnt(4)
    v_mul_f32 v224, v144, v32
    v_mul_f32 v226, v160, v32
    v_fmac_f32 v224, v160, v48
    v_mfma_f32_32x32x16_bf16 v[176:191], v[136:139], v[0:3], 0
    v_fma_f32 v226, -v144, v48, v226
    v_mul_f32 v225, v145, v33
    v_mul_f32 v227, v161, v33
    v_fmac_f32 v225, v161, v49
    v_fma_f32 v227, -v145, v49, v227
    v_cvt_pk_bf16_f32 v208, v224, v225
    v_cvt_pk_bf16_f32 v216, v226, v227
    v_mul_f32 v228, v146, v34
    v_mul_f32 v230, v162, v34
    v_fmac_f32 v228, v162, v50
    v_mfma_f32_32x32x16_bf16 v[192:207], v[136:139], v[8:11], 0
    v_fma_f32 v230, -v146, v50, v230
    v_mul_f32 v229, v147, v35
    v_mul_f32 v231, v163, v35
    v_fmac_f32 v229, v163, v51
    v_fma_f32 v231, -v147, v51, v231
    v_cvt_pk_bf16_f32 v209, v228, v229
    v_cvt_pk_bf16_f32 v217, v230, v231
    v_mul_f32 v224, v148, v36
    v_mul_f32 v226, v164, v36
    v_fmac_f32 v224, v164, v52
    v_mfma_f32_32x32x16_bf16 v[176:191], v[140:143], v[4:7], v[176:191]
    v_fma_f32 v226, -v148, v52, v226
    v_mul_f32 v225, v149, v37
    v_mul_f32 v227, v165, v37
    v_fmac_f32 v225, v165, v53
    v_fma_f32 v227, -v149, v53, v227
    v_cvt_pk_bf16_f32 v210, v224, v225
    v_cvt_pk_bf16_f32 v218, v226, v227
    v_mul_f32 v228, v150, v38
    v_mul_f32 v230, v166, v38
    v_fmac_f32 v228, v166, v54
    v_mfma_f32_32x32x16_bf16 v[192:207], v[140:143], v[12:15], v[192:207]
    v_fma_f32 v230, -v150, v54, v230
    v_mul_f32 v229, v151, v39
    v_mul_f32 v231, v167, v39
    v_fmac_f32 v229, v167, v55
    ds_read_b64_tr_b16 v[136:137], v252 offset:6192
    ds_read_b64_tr_b16 v[138:139], v252 offset:6448
    ds_read_b64_tr_b16 v[140:141], v252 offset:7216
    ds_read_b64_tr_b16 v[142:143], v252 offset:7472
    v_fma_f32 v231, -v151, v55, v231
    v_cvt_pk_bf16_f32 v211, v228, v229
    v_cvt_pk_bf16_f32 v219, v230, v231
    v_mul_f32 v224, v152, v40
    v_mul_f32 v226, v168, v40
    v_fmac_f32 v224, v168, v56
    v_fma_f32 v226, -v152, v56, v226
    v_mul_f32 v225, v153, v41
    v_mul_f32 v227, v169, v41
    v_fmac_f32 v225, v169, v57
    v_fma_f32 v227, -v153, v57, v227
    v_cvt_pk_bf16_f32 v212, v224, v225
    v_cvt_pk_bf16_f32 v220, v226, v227
    v_mul_f32 v228, v154, v42
    v_mul_f32 v230, v170, v42
    v_fmac_f32 v228, v170, v58
    v_fma_f32 v230, -v154, v58, v230
    v_mul_f32 v229, v155, v43
    v_mul_f32 v231, v171, v43
    v_fmac_f32 v229, v171, v59
    v_fma_f32 v231, -v155, v59, v231
    v_cvt_pk_bf16_f32 v213, v228, v229
    v_cvt_pk_bf16_f32 v221, v230, v231
    v_mul_f32 v224, v156, v44
    v_mul_f32 v226, v172, v44
    v_fmac_f32 v224, v172, v60
    v_fma_f32 v226, -v156, v60, v226
    v_mul_f32 v225, v157, v45
    v_mul_f32 v227, v173, v45
    v_fmac_f32 v225, v173, v61
    v_fma_f32 v227, -v157, v61, v227
    v_cvt_pk_bf16_f32 v214, v224, v225
    v_cvt_pk_bf16_f32 v222, v226, v227
    v_mul_f32 v228, v158, v46
    v_mul_f32 v230, v174, v46
    v_fmac_f32 v228, v174, v62
    v_fma_f32 v230, -v158, v62, v230
    v_mul_f32 v229, v159, v47
    v_mul_f32 v231, v175, v47
    v_fmac_f32 v229, v175, v63
    v_fma_f32 v231, -v159, v63, v231
    v_cvt_pk_bf16_f32 v215, v228, v229
    v_cvt_pk_bf16_f32 v223, v230, v231
    s_waitcnt lgkmcnt(4)
    v_mul_f32 v224, v176, v32
    v_mul_f32 v226, v192, v32
    v_fmac_f32 v224, v192, v48
    v_mfma_f32_32x32x16_bf16 v[144:159], v[128:131], v[0:3], 0
    v_fma_f32 v226, -v176, v48, v226
    v_mul_f32 v225, v177, v33
    v_mul_f32 v227, v193, v33
    v_fmac_f32 v225, v193, v49
    v_fma_f32 v227, -v177, v49, v227
    v_cvt_pk_bf16_f32 v232, v224, v225
    v_cvt_pk_bf16_f32 v240, v226, v227
    v_mul_f32 v228, v178, v34
    v_mul_f32 v230, v194, v34
    v_fmac_f32 v228, v194, v50
    v_mfma_f32_32x32x16_bf16 v[160:175], v[128:131], v[8:11], 0
    v_fma_f32 v230, -v178, v50, v230
    v_mul_f32 v229, v179, v35
    v_mul_f32 v231, v195, v35
    v_fmac_f32 v229, v195, v51
    v_fma_f32 v231, -v179, v51, v231
    v_cvt_pk_bf16_f32 v233, v228, v229
    v_cvt_pk_bf16_f32 v241, v230, v231
    v_mul_f32 v224, v180, v36
    v_mul_f32 v226, v196, v36
    v_fmac_f32 v224, v196, v52
    v_mfma_f32_32x32x16_bf16 v[144:159], v[132:135], v[4:7], v[144:159]
    v_fma_f32 v226, -v180, v52, v226
    v_mul_f32 v225, v181, v37
    v_mul_f32 v227, v197, v37
    v_fmac_f32 v225, v197, v53
    v_fma_f32 v227, -v181, v53, v227
    v_cvt_pk_bf16_f32 v234, v224, v225
    v_cvt_pk_bf16_f32 v242, v226, v227
    v_mul_f32 v228, v182, v38
    v_mul_f32 v230, v198, v38
    v_fmac_f32 v228, v198, v54
    v_mfma_f32_32x32x16_bf16 v[160:175], v[132:135], v[12:15], v[160:175]
    v_fma_f32 v230, -v182, v54, v230
    v_mul_f32 v229, v183, v39
    v_mul_f32 v231, v199, v39
    v_fmac_f32 v229, v199, v55
    v_fma_f32 v231, -v183, v55, v231
    v_cvt_pk_bf16_f32 v235, v228, v229
    v_cvt_pk_bf16_f32 v243, v230, v231
    v_mul_f32 v224, v184, v40
    v_mul_f32 v226, v200, v40
    v_fmac_f32 v224, v200, v56
    v_mfma_f32_32x32x16_bf16 v[64:79], v[16:19], v[208:211], 0
    v_fma_f32 v226, -v184, v56, v226
    v_mul_f32 v225, v185, v41
    v_mul_f32 v227, v201, v41
    v_fmac_f32 v225, v201, v57
    v_fma_f32 v227, -v185, v57, v227
    v_cvt_pk_bf16_f32 v236, v224, v225
    v_cvt_pk_bf16_f32 v244, v226, v227
    v_mul_f32 v228, v186, v42
    v_mul_f32 v230, v202, v42
    v_fmac_f32 v228, v202, v58
    v_mfma_f32_32x32x16_bf16 v[64:79], v[20:23], v[212:215], v[64:79]
    v_fma_f32 v230, -v186, v58, v230
    v_mul_f32 v229, v187, v43
    v_mul_f32 v231, v203, v43
    v_fmac_f32 v229, v203, v59
    v_fma_f32 v231, -v187, v59, v231
    v_cvt_pk_bf16_f32 v237, v228, v229
    v_cvt_pk_bf16_f32 v245, v230, v231
    v_mul_f32 v224, v188, v44
    v_mul_f32 v226, v204, v44
    v_fmac_f32 v224, v204, v60
    v_mfma_f32_32x32x16_bf16 v[64:79], v[24:27], v[216:219], v[64:79]
    v_fma_f32 v226, -v188, v60, v226
    v_mul_f32 v225, v189, v45
    v_mul_f32 v227, v205, v45
    v_fmac_f32 v225, v205, v61
    v_fma_f32 v227, -v189, v61, v227
    v_cvt_pk_bf16_f32 v238, v224, v225
    v_cvt_pk_bf16_f32 v246, v226, v227
    v_mul_f32 v228, v190, v46
    v_mul_f32 v230, v206, v46
    v_fmac_f32 v228, v206, v62
    v_mfma_f32_32x32x16_bf16 v[64:79], v[28:31], v[220:223], v[64:79]
    v_fma_f32 v230, -v190, v62, v230
    v_mul_f32 v229, v191, v47
    v_mul_f32 v231, v207, v47
    v_fmac_f32 v229, v207, v63
    v_fma_f32 v231, -v191, v63, v231
    v_cvt_pk_bf16_f32 v239, v228, v229
    v_cvt_pk_bf16_f32 v247, v230, v231
    s_waitcnt lgkmcnt(0)
    v_mul_f32 v224, v144, v32
    v_mul_f32 v226, v160, v32
    v_fmac_f32 v224, v160, v48
    v_mfma_f32_32x32x16_bf16 v[176:191], v[136:139], v[0:3], 0
    v_fma_f32 v226, -v144, v48, v226
    v_mul_f32 v225, v145, v33
    v_mul_f32 v227, v161, v33
    v_fmac_f32 v225, v161, v49
    v_fma_f32 v227, -v145, v49, v227
    v_cvt_pk_bf16_f32 v208, v224, v225
    v_cvt_pk_bf16_f32 v216, v226, v227
    v_mul_f32 v228, v146, v34
    v_mul_f32 v230, v162, v34
    v_fmac_f32 v228, v162, v50
    v_mfma_f32_32x32x16_bf16 v[192:207], v[136:139], v[8:11], 0
    v_fma_f32 v230, -v146, v50, v230
    v_mul_f32 v229, v147, v35
    v_mul_f32 v231, v163, v35
    v_fmac_f32 v229, v163, v51
    v_fma_f32 v231, -v147, v51, v231
    v_cvt_pk_bf16_f32 v209, v228, v229
    v_cvt_pk_bf16_f32 v217, v230, v231
    v_mul_f32 v224, v148, v36
    v_mul_f32 v226, v164, v36
    v_fmac_f32 v224, v164, v52
    v_mfma_f32_32x32x16_bf16 v[176:191], v[140:143], v[4:7], v[176:191]
    v_fma_f32 v226, -v148, v52, v226
    v_mul_f32 v225, v149, v37
    v_mul_f32 v227, v165, v37
    v_fmac_f32 v225, v165, v53
    v_fma_f32 v227, -v149, v53, v227
    v_cvt_pk_bf16_f32 v210, v224, v225
    v_cvt_pk_bf16_f32 v218, v226, v227
    v_mul_f32 v228, v150, v38
    v_mul_f32 v230, v166, v38
    v_fmac_f32 v228, v166, v54
    v_mfma_f32_32x32x16_bf16 v[192:207], v[140:143], v[12:15], v[192:207]
    v_fma_f32 v230, -v150, v54, v230
    v_mul_f32 v229, v151, v39
    v_mul_f32 v231, v167, v39
    v_fmac_f32 v229, v167, v55
    v_fma_f32 v231, -v151, v55, v231
    v_cvt_pk_bf16_f32 v211, v228, v229
    v_cvt_pk_bf16_f32 v219, v230, v231
    v_mul_f32 v224, v152, v40
    v_mul_f32 v226, v168, v40
    v_fmac_f32 v224, v168, v56
    v_mfma_f32_32x32x16_bf16 v[80:95], v[16:19], v[232:235], 0
    v_fma_f32 v226, -v152, v56, v226
    v_mul_f32 v225, v153, v41
    v_mul_f32 v227, v169, v41
    v_fmac_f32 v225, v169, v57
    v_fma_f32 v227, -v153, v57, v227
    v_cvt_pk_bf16_f32 v212, v224, v225
    v_cvt_pk_bf16_f32 v220, v226, v227
    v_mul_f32 v228, v154, v42
    v_mul_f32 v230, v170, v42
    v_fmac_f32 v228, v170, v58
    v_mfma_f32_32x32x16_bf16 v[80:95], v[20:23], v[236:239], v[80:95]
    v_fma_f32 v230, -v154, v58, v230
    v_mul_f32 v229, v155, v43
    v_mul_f32 v231, v171, v43
    v_fmac_f32 v229, v171, v59
    v_fma_f32 v231, -v155, v59, v231
    v_cvt_pk_bf16_f32 v213, v228, v229
    v_cvt_pk_bf16_f32 v221, v230, v231
    v_mul_f32 v224, v156, v44
    v_mul_f32 v226, v172, v44
    v_fmac_f32 v224, v172, v60
    v_mfma_f32_32x32x16_bf16 v[80:95], v[24:27], v[240:243], v[80:95]
    v_fma_f32 v226, -v156, v60, v226
    v_mul_f32 v225, v157, v45
    v_mul_f32 v227, v173, v45
    v_fmac_f32 v225, v173, v61
    v_fma_f32 v227, -v157, v61, v227
    v_cvt_pk_bf16_f32 v214, v224, v225
    v_cvt_pk_bf16_f32 v222, v226, v227
    v_mul_f32 v228, v158, v46
    v_mul_f32 v230, v174, v46
    v_fmac_f32 v228, v174, v62
    v_mfma_f32_32x32x16_bf16 v[80:95], v[28:31], v[244:247], v[80:95]
    v_fma_f32 v230, -v158, v62, v230
    v_mul_f32 v229, v159, v47
    v_mul_f32 v231, v175, v47
    v_fmac_f32 v229, v175, v63
    v_fma_f32 v231, -v159, v63, v231
    v_cvt_pk_bf16_f32 v215, v228, v229
    v_cvt_pk_bf16_f32 v223, v230, v231
    v_mul_f32 v224, v176, v32
    v_mul_f32 v226, v192, v32
    v_fmac_f32 v224, v192, v48
    v_mfma_f32_32x32x16_bf16 v[96:111], v[16:19], v[208:211], 0
    v_fma_f32 v226, -v176, v48, v226
    v_mul_f32 v225, v177, v33
    v_mul_f32 v227, v193, v33
    v_fmac_f32 v225, v193, v49
    v_fma_f32 v227, -v177, v49, v227
    v_cvt_pk_bf16_f32 v232, v224, v225
    v_cvt_pk_bf16_f32 v240, v226, v227
    v_mul_f32 v228, v178, v34
    v_mul_f32 v230, v194, v34
    v_fmac_f32 v228, v194, v50
    v_mfma_f32_32x32x16_bf16 v[96:111], v[20:23], v[212:215], v[96:111]
    v_fma_f32 v230, -v178, v50, v230
    v_mul_f32 v229, v179, v35
    v_mul_f32 v231, v195, v35
    v_fmac_f32 v229, v195, v51
    v_fma_f32 v231, -v179, v51, v231
    v_cvt_pk_bf16_f32 v233, v228, v229
    v_cvt_pk_bf16_f32 v241, v230, v231
    v_mul_f32 v224, v180, v36
    v_mul_f32 v226, v196, v36
    v_fmac_f32 v224, v196, v52
    v_mfma_f32_32x32x16_bf16 v[96:111], v[24:27], v[216:219], v[96:111]
    v_fma_f32 v226, -v180, v52, v226
    v_mul_f32 v225, v181, v37
    v_mul_f32 v227, v197, v37
    v_fmac_f32 v225, v197, v53
    v_fma_f32 v227, -v181, v53, v227
    v_cvt_pk_bf16_f32 v234, v224, v225
    v_cvt_pk_bf16_f32 v242, v226, v227
    v_mul_f32 v228, v182, v38
    v_mul_f32 v230, v198, v38
    v_fmac_f32 v228, v198, v54
    v_mfma_f32_32x32x16_bf16 v[96:111], v[28:31], v[220:223], v[96:111]
    v_fma_f32 v230, -v182, v54, v230
    v_mul_f32 v229, v183, v39
    v_mul_f32 v231, v199, v39
    v_fmac_f32 v229, v199, v55
    v_fma_f32 v231, -v183, v55, v231
    v_cvt_pk_bf16_f32 v235, v228, v229
    v_cvt_pk_bf16_f32 v243, v230, v231
    v_mul_f32 v224, v184, v40
    v_mul_f32 v226, v200, v40
    v_fmac_f32 v224, v200, v56
    v_fma_f32 v226, -v184, v56, v226
    v_mul_f32 v225, v185, v41
    v_mul_f32 v227, v201, v41
    v_fmac_f32 v225, v201, v57
    v_fma_f32 v227, -v185, v57, v227
    v_cvt_pk_bf16_f32 v236, v224, v225
    v_cvt_pk_bf16_f32 v244, v226, v227
    v_mul_f32 v228, v186, v42
    v_mul_f32 v230, v202, v42
    v_fmac_f32 v228, v202, v58
    v_fma_f32 v230, -v186, v58, v230
    v_mul_f32 v229, v187, v43
    v_mul_f32 v231, v203, v43
    v_fmac_f32 v229, v203, v59
    v_fma_f32 v231, -v187, v59, v231
    v_cvt_pk_bf16_f32 v237, v228, v229
    v_cvt_pk_bf16_f32 v245, v230, v231
    v_mul_f32 v224, v188, v44
    v_mul_f32 v226, v204, v44
    v_fmac_f32 v224, v204, v60
    v_fma_f32 v226, -v188, v60, v226
    v_mul_f32 v225, v189, v45
    v_mul_f32 v227, v205, v45
    v_fmac_f32 v225, v205, v61
    v_fma_f32 v227, -v189, v61, v227
    v_cvt_pk_bf16_f32 v238, v224, v225
    v_cvt_pk_bf16_f32 v246, v226, v227
    v_mul_f32 v228, v190, v46
    v_mul_f32 v230, v206, v46
    v_fmac_f32 v228, v206, v62
    v_fma_f32 v230, -v190, v62, v230
    v_mul_f32 v229, v191, v47
    v_mul_f32 v231, v207, v47
    v_fmac_f32 v229, v207, v63
    v_fma_f32 v231, -v191, v63, v231
    v_cvt_pk_bf16_f32 v239, v228, v229
    v_cvt_pk_bf16_f32 v247, v230, v231
    s_nop 1
    v_mfma_f32_32x32x16_bf16 v[112:127], v[16:19], v[232:235], 0
    v_mfma_f32_32x32x16_bf16 v[112:127], v[20:23], v[236:239], v[112:127]
    v_mfma_f32_32x32x16_bf16 v[112:127], v[24:27], v[240:243], v[112:127]
    v_mfma_f32_32x32x16_bf16 v[112:127], v[28:31], v[244:247], v[112:127]
    s_waitcnt lgkmcnt(0)
    s_barrier
    s_nop 7
    s_nop 1
    v_cvt_pk_bf16_f32 v224, v64, v80
    v_cvt_pk_bf16_f32 v225, v96, v112
    ds_write_b64 v248, v[224:225] offset:0
    v_cvt_pk_bf16_f32 v226, v65, v81
    v_cvt_pk_bf16_f32 v227, v97, v113
    ds_write_b64 v249, v[226:227] offset:0
    v_cvt_pk_bf16_f32 v228, v66, v82
    v_cvt_pk_bf16_f32 v229, v98, v114
    ds_write_b64 v250, v[228:229] offset:0
    v_cvt_pk_bf16_f32 v230, v67, v83
    v_cvt_pk_bf16_f32 v231, v99, v115
    ds_write_b64 v251, v[230:231] offset:0
    v_cvt_pk_bf16_f32 v224, v68, v84
    v_cvt_pk_bf16_f32 v225, v100, v116
    ds_write_b64 v248, v[224:225] offset:2048
    v_cvt_pk_bf16_f32 v226, v69, v85
    v_cvt_pk_bf16_f32 v227, v101, v117
    ds_write_b64 v249, v[226:227] offset:2048
    v_cvt_pk_bf16_f32 v228, v70, v86
    v_cvt_pk_bf16_f32 v229, v102, v118
    ds_write_b64 v250, v[228:229] offset:2048
    v_cvt_pk_bf16_f32 v230, v71, v87
    v_cvt_pk_bf16_f32 v231, v103, v119
    ds_write_b64 v251, v[230:231] offset:2048
    v_cvt_pk_bf16_f32 v224, v72, v88
    v_cvt_pk_bf16_f32 v225, v104, v120
    ds_write_b64 v248, v[224:225] offset:33792
    v_cvt_pk_bf16_f32 v226, v73, v89
    v_cvt_pk_bf16_f32 v227, v105, v121
    ds_write_b64 v249, v[226:227] offset:33792
    v_cvt_pk_bf16_f32 v228, v74, v90
    v_cvt_pk_bf16_f32 v229, v106, v122
    ds_write_b64 v250, v[228:229] offset:33792
    v_cvt_pk_bf16_f32 v230, v75, v91
    v_cvt_pk_bf16_f32 v231, v107, v123
    ds_write_b64 v251, v[230:231] offset:33792
    v_cvt_pk_bf16_f32 v224, v76, v92
    v_cvt_pk_bf16_f32 v225, v108, v124
    ds_write_b64 v248, v[224:225] offset:35840
    v_cvt_pk_bf16_f32 v226, v77, v93
    v_cvt_pk_bf16_f32 v227, v109, v125
    ds_write_b64 v249, v[226:227] offset:35840
    v_cvt_pk_bf16_f32 v228, v78, v94
    v_cvt_pk_bf16_f32 v229, v110, v126
    ds_write_b64 v250, v[228:229] offset:35840
    v_cvt_pk_bf16_f32 v230, v79, v95
    v_cvt_pk_bf16_f32 v231, v111, v127
    ds_write_b64 v251, v[230:231] offset:35840
    s_waitcnt lgkmcnt(0)
    s_barrier
    s_cmp_eq_u32 s28, 1
    s_cbranch_scc1 fft_nonext
    s_add_u32 s27, s27, 32
    v_lshlrev_b32 v224, 4, v255
    s_lshl_b32 s29, s24, 2
    s_mul_i32 s30, s29, 2064
    s_lshl_b32 s31, s29, 6
    s_add_u32 s31, s31, s27
    s_lshl_b32 s31, s31, 11
    s_add_u32 m0, s30, 0
    s_add_u32 s32, s31, 0
    buffer_load_dwordx4 v224, s[12:15], s32 offen  lds
    buffer_load_dwordx4 v224, s[12:15], s32 offen offset:1024  lds
    s_add_u32 m0, s30, 2064
    s_add_u32 s32, s31, 131072
    buffer_load_dwordx4 v224, s[12:15], s32 offen  lds
    buffer_load_dwordx4 v224, s[12:15], s32 offen offset:1024  lds
    s_add_u32 m0, s30, 4128
    s_add_u32 s32, s31, 262144
    buffer_load_dwordx4 v224, s[12:15], s32 offen  lds
    buffer_load_dwordx4 v224, s[12:15], s32 offen offset:1024  lds
    s_add_u32 m0, s30, 6192
    s_add_u32 s32, s31, 393216
    buffer_load_dwordx4 v224, s[12:15], s32 offen  lds
    buffer_load_dwordx4 v224, s[12:15], s32 offen offset:1024  lds
    s_sub_u32 s27, s27, 32
    s_branch fft_next_done
fft_nonext:
    s_cmp_ge_u32 s24, 4
    s_cbranch_scc1 nonce_req_3252
    v_mov_b32 v251, 0
    buffer_load_dword v250, v251, s[88:91], 0 offen sc1
nonce_req_3252:
fft_next_done:
    s_and_b32 s29, s24, 1
    s_lshr_b32 s30, s24, 1
    s_lshl_b32 s31, s29, 11
    s_add_u32 s32, s31, s35
    v_lshl_add_u32 v100, v255, 4, s32
    s_xor_b32 s31, s31, 2048
    s_add_u32 s32, s31, s35
    v_lshl_add_u32 v101, v255, 4, s32
    ds_read_b128 v[232:235], v100
    ds_read_b128 v[236:239], v100 offset:1024
    ds_read_b128 v[240:243], v101
    ds_read_b128 v[244:247], v101 offset:1024
    v_and_b32 v100, 31, v255
    v_lshlrev_b32 v101, 2, v100
    v_add_u32 v101, s34, v101
    s_cmp_lg_u32 s24, 0
    s_cbranch_scc1 fft_nogate
    ds_read_b32 v102, v101
    s_waitcnt lgkmcnt(0)
    v_mul_f32 v102, 0xbfb8aa3b, v102
    v_exp_f32 v102, v102
    s_nop 0
    v_add_f32 v102, 1.0, v102
    v_rcp_f32 v102, v102
    s_and_b32 s31, s27, 31
    s_lshl_b32 s31, s31, 6
    s_lshr_b32 s32, s27, 5
    s_add_u32 s31, s31, s32
    s_lshl_b32 s31, s31, 2
    v_lshlrev_b32 v104, 3, v100
    buffer_store_dword v102, v104, s[36:39], s31 offen sc1
fft_nogate:
    s_cmp_lg_u32 s30, 2
    s_cbranch_scc1 fft_nonyq
    ds_read_b32 v103, v101 offset:128
    s_waitcnt lgkmcnt(0)
    v_cvt_pk_bf16_f32 v103, v103, v103
    v_lshlrev_b32 v104, 1, v100
    v_add_u32 v104, 70656, v104
    ds_write_b16 v104, v103
fft_nonyq:
    s_lshr_b32 s31, s30, 1
    s_xor_b32 s32, s31, s29
    s_cmp_eq_u32 s32, 1
    s_cselect_b32 s33, 0x80008000, 0
    s_waitcnt lgkmcnt(0)
    v_xor_b32 v240, s33, v240
    v_xor_b32 v241, s33, v241
    v_xor_b32 v242, s33, v242
    v_xor_b32 v243, s33, v243
    v_xor_b32 v244, s33, v244
    v_xor_b32 v245, s33, v245
    v_xor_b32 v246, s33, v246
    v_xor_b32 v247, s33, v247
    s_cmp_ge_u32 s24, 4
    s_cbranch_scc1 fft_noprio
    s_setprio 1
fft_noprio:
    v_and_b32 v224, 31, v255
    v_lshrrev_b32 v225, 5, v255
    s_lshl_b32 s32, s30, 5
    v_add_u32 v226, s32, v224
    v_sub_u32 v227, 127, v226
    s_cmp_eq_u32 s31, 1
    s_cselect_b64 vcc, -1, 0
    v_cndmask_b32 v226, v226, v227, vcc
    s_mov_b32 s32, 0
    s_cmp_eq_u32 s31, 1
    s_cselect_b32 s32, 1, s32
    v_add_u32 v228, s32, v226
    v_bfe_u32 v229, v228, 2, 2
    v_xor_b32 v229, v229, v225
    v_lshlrev_b32 v229, 4, v229
    v_lshl_add_u32 v228, v228, 6, v229
    v_add_u32 v228, 66560, v228
    v_xor_b32 v229, 32, v228
    ds_read_b128 v[192:195], v228
    ds_read_b128 v[196:199], v229
    ds_read_b128 v[200:203], v228 offset:33792
    ds_read_b128 v[204:207], v229 offset:33792
    s_mov_b32 s32, 66
    s_cmp_eq_u32 s31, 1
    s_cselect_b32 s32, 462, s32
    v_add_u32 v228, s32, v226
    v_bfe_u32 v229, v228, 2, 2
    v_xor_b32 v229, v229, v225
    v_lshlrev_b32 v229, 4, v229
    v_lshl_add_u32 v228, v228, 6, v229
    v_add_u32 v228, 66560, v228
    v_xor_b32 v229, 32, v228
    ds_read_b128 v[208:211], v228
    ds_read_b128 v[212:215], v229
    ds_read_b128 v[216:219], v228 offset:33792
    ds_read_b128 v[220:223], v229 offset:33792
    s_waitcnt lgkmcnt(4)
    v_mfma_f32_32x32x16_bf16 v[64:79], v[232:235], v[192:195], 0
    v_mfma_f32_32x32x16_bf16 v[64:79], v[236:239], v[196:199], v[64:79]
    v_mfma_f32_32x32x16_bf16 v[64:79], v[240:243], v[200:203], v[64:79]
    v_mfma_f32_32x32x16_bf16 v[64:79], v[244:247], v[204:207], v[64:79]
    s_mov_b32 s32, 132
    s_cmp_eq_u32 s31, 1
    s_cselect_b32 s32, 396, s32
    v_add_u32 v228, s32, v226
    v_bfe_u32 v229, v228, 2, 2
    v_xor_b32 v229, v229, v225
    v_lshlrev_b32 v229, 4, v229
    v_lshl_add_u32 v228, v228, 6, v229
    v_add_u32 v228, 66560, v228
    v_xor_b32 v229, 32, v228
    ds_read_b128 v[192:195], v228
    ds_read_b128 v[196:199], v229
    ds_read_b128 v[200:203], v228 offset:33792
    ds_read_b128 v[204:207], v229 offset:33792
    s_waitcnt lgkmcnt(4)
    v_mfma_f32_32x32x16_bf16 v[80:95], v[232:235], v[208:211], 0
    v_mfma_f32_32x32x16_bf16 v[80:95], v[236:239], v[212:215], v[80:95]
    v_mfma_f32_32x32x16_bf16 v[80:95], v[240:243], v[216:219], v[80:95]
    v_mfma_f32_32x32x16_bf16 v[80:95], v[244:247], v[220:223], v[80:95]
    s_mov_b32 s32, 198
    s_cmp_eq_u32 s31, 1
    s_cselect_b32 s32, 330, s32
    v_add_u32 v228, s32, v226
    v_bfe_u32 v229, v228, 2, 2
    v_xor_b32 v229, v229, v225
    v_lshlrev_b32 v229, 4, v229
    v_lshl_add_u32 v228, v228, 6, v229
    v_add_u32 v228, 66560, v228
    v_xor_b32 v229, 32, v228
    ds_read_b128 v[208:211], v228
    ds_read_b128 v[212:215], v229
    ds_read_b128 v[216:219], v228 offset:33792
    ds_read_b128 v[220:223], v229 offset:33792
    s_waitcnt lgkmcnt(4)
    v_mfma_f32_32x32x16_bf16 v[96:111], v[232:235], v[192:195], 0
    v_mfma_f32_32x32x16_bf16 v[96:111], v[236:239], v[196:199], v[96:111]
    v_mfma_f32_32x32x16_bf16 v[96:111], v[240:243], v[200:203], v[96:111]
    v_mfma_f32_32x32x16_bf16 v[96:111], v[244:247], v[204:207], v[96:111]
    s_mov_b32 s32, 264
    s_cmp_eq_u32 s31, 1
    s_cselect_b32 s32, 264, s32
    v_add_u32 v228, s32, v226
    v_bfe_u32 v229, v228, 2, 2
    v_xor_b32 v229, v229, v225
    v_lshlrev_b32 v229, 4, v229
    v_lshl_add_u32 v228, v228, 6, v229
    v_add_u32 v228, 66560, v228
    v_xor_b32 v229, 32, v228
    ds_read_b128 v[192:195], v228
    ds_read_b128 v[196:199], v229
    ds_read_b128 v[200:203], v228 offset:33792
    ds_read_b128 v[204:207], v229 offset:33792
    s_waitcnt lgkmcnt(4)
    v_mfma_f32_32x32x16_bf16 v[112:127], v[232:235], v[208:211], 0
    v_mfma_f32_32x32x16_bf16 v[112:127], v[236:239], v[212:215], v[112:127]
    v_mfma_f32_32x32x16_bf16 v[112:127], v[240:243], v[216:219], v[112:127]
    v_mfma_f32_32x32x16_bf16 v[112:127], v[244:247], v[220:223], v[112:127]
    s_mov_b32 s32, 330
    s_cmp_eq_u32 s31, 1
    s_cselect_b32 s32, 198, s32
    v_add_u32 v228, s32, v226
    v_bfe_u32 v229, v228, 2, 2
    v_xor_b32 v229, v229, v225
    v_lshlrev_b32 v229, 4, v229
    v_lshl_add_u32 v228, v228, 6, v229
    v_add_u32 v228, 66560, v228
    v_xor_b32 v229, 32, v228
    ds_read_b128 v[208:211], v228
    ds_read_b128 v[212:215], v229
    ds_read_b128 v[216:219], v228 offset:33792
    ds_read_b128 v[220:223], v229 offset:33792
    s_waitcnt lgkmcnt(4)
    v_mfma_f32_32x32x16_bf16 v[128:143], v[232:235], v[192:195], 0
    v_mfma_f32_32x32x16_bf16 v[128:143], v[236:239], v[196:199], v[128:143]
    v_mfma_f32_32x32x16_bf16 v[128:143], v[240:243], v[200:203], v[128:143]
    v_mfma_f32_32x32x16_bf16 v[128:143], v[244:247], v[204:207], v[128:143]
    s_mov_b32 s32, 396
    s_cmp_eq_u32 s31, 1
    s_cselect_b32 s32, 132, s32
    v_add_u32 v228, s32, v226
    v_bfe_u32 v229, v228, 2, 2
    v_xor_b32 v229, v229, v225
    v_lshlrev_b32 v229, 4, v229
    v_lshl_add_u32 v228, v228, 6, v229
    v_add_u32 v228, 66560, v228
    v_xor_b32 v229, 32, v228
    ds_read_b128 v[192:195], v228
    ds_read_b128 v[196:199], v229
    ds_read_b128 v[200:203], v228 offset:33792
    ds_read_b128 v[204:207], v229 offset:33792
    s_waitcnt lgkmcnt(4)
    v_mfma_f32_32x32x16_bf16 v[144:159], v[232:235], v[208:211], 0
    v_mfma_f32_32x32x16_bf16 v[144:159], v[236:239], v[212:215], v[144:159]
    v_mfma_f32_32x32x16_bf16 v[144:159], v[240:243], v[216:219], v[144:159]
    v_mfma_f32_32x32x16_bf16 v[144:159], v[244:247], v[220:223], v[144:159]
    s_mov_b32 s32, 462
    s_cmp_eq_u32 s31, 1
    s_cselect_b32 s32, 66, s32
    v_add_u32 v228, s32, v226
    v_bfe_u32 v229, v228, 2, 2
    v_xor_b32 v229, v229, v225
    v_lshlrev_b32 v229, 4, v229
    v_lshl_add_u32 v228, v228, 6, v229
    v_add_u32 v228, 66560, v228
    v_xor_b32 v229, 32, v228
    ds_read_b128 v[208:211], v228
    ds_read_b128 v[212:215], v229
    ds_read_b128 v[216:219], v228 offset:33792
    ds_read_b128 v[220:223], v229 offset:33792
    s_waitcnt lgkmcnt(4)
    v_mfma_f32_32x32x16_bf16 v[160:175], v[232:235], v[192:195], 0
    v_mfma_f32_32x32x16_bf16 v[160:175], v[236:239], v[196:199], v[160:175]
    v_mfma_f32_32x32x16_bf16 v[160:175], v[240:243], v[200:203], v[160:175]
    v_mfma_f32_32x32x16_bf16 v[160:175], v[244:247], v[204:207], v[160:175]
    s_waitcnt lgkmcnt(0)
    v_mfma_f32_32x32x16_bf16 v[176:191], v[232:235], v[208:211], 0
    v_mfma_f32_32x32x16_bf16 v[176:191], v[236:239], v[212:215], v[176:191]
    v_mfma_f32_32x32x16_bf16 v[176:191], v[240:243], v[216:219], v[176:191]
    v_mfma_f32_32x32x16_bf16 v[176:191], v[244:247], v[220:223], v[176:191]
    s_setprio 0
    s_add_u32 s40, s40, 1
    s_waitcnt vmcnt(0)
    s_lshl_b32 s41, s24, 2
    s_add_u32 s41, s41, 152576
    v_mov_b32 v230, s41
    v_mov_b32 v231, s40
    ds_write_b32 v230, v231
    v_lshrrev_b32 v226, 4, v224
    s_lshl_b32 s32, s30, 1
    v_add_u32 v227, s32, v226
    v_xor_b32 v227, v227, v225
    v_lshlrev_b32 v227, 3, v227
    s_xor_b32 s32, s27, s29
    v_xor_b32 v227, s32, v227
    v_lshlrev_b32 v227, 8, v227
    v_lshlrev_b32 v225, 20, v225
    v_lshl_add_u32 v225, v226, 14, v225
    v_and_b32 v224, 15, v224
    v_lshl_add_u32 v224, v224, 4, v225
    v_add_u32 v224, v224, v227
    s_lshl_b32 s32, s29, 17
    s_lshl_b32 s33, s30, 15
    s_add_u32 s32, s32, s33
    v_cvt_pk_bf16_f32 v192, v64, v80
    v_cvt_pk_bf16_f32 v193, v96, v112
    v_cvt_pk_bf16_f32 v194, v128, v144
    v_cvt_pk_bf16_f32 v195, v160, v176
    v_xor_b32 v226, 0, v224
    s_add_u32 s33, s32, 0
    buffer_store_dwordx4 v[192:195], v226, s[76:79], s33 offen sc1
    v_cvt_pk_bf16_f32 v196, v65, v81
    v_cvt_pk_bf16_f32 v197, v97, v113
    v_cvt_pk_bf16_f32 v198, v129, v145
    v_cvt_pk_bf16_f32 v199, v161, v177
    v_xor_b32 v227, 512, v224
    s_add_u32 s33, s32, 262144
    buffer_store_dwordx4 v[196:199], v227, s[76:79], s33 offen sc1
    v_cvt_pk_bf16_f32 v200, v66, v82
    v_cvt_pk_bf16_f32 v201, v98, v114
    v_cvt_pk_bf16_f32 v202, v130, v146
    v_cvt_pk_bf16_f32 v203, v162, v178
    v_xor_b32 v226, 1024, v224
    s_add_u32 s33, s32, 524288
    buffer_store_dwordx4 v[200:203], v226, s[76:79], s33 offen sc1
    v_cvt_pk_bf16_f32 v204, v67, v83
    v_cvt_pk_bf16_f32 v205, v99, v115
    v_cvt_pk_bf16_f32 v206, v131, v147
    v_cvt_pk_bf16_f32 v207, v163, v179
    v_xor_b32 v227, 1536, v224
    s_add_u32 s33, s32, 786432
    buffer_store_dwordx4 v[204:207], v227, s[76:79], s33 offen sc1
    v_cvt_pk_bf16_f32 v208, v68, v84
    v_cvt_pk_bf16_f32 v209, v100, v116
    v_cvt_pk_bf16_f32 v210, v132, v148
    v_cvt_pk_bf16_f32 v211, v164, v180
    v_xor_b32 v226, 4096, v224
    s_add_u32 s33, s32, 2097152
    buffer_store_dwordx4 v[208:211], v226, s[76:79], s33 offen sc1
    v_cvt_pk_bf16_f32 v212, v69, v85
    v_cvt_pk_bf16_f32 v213, v101, v117
    v_cvt_pk_bf16_f32 v214, v133, v149
    v_cvt_pk_bf16_f32 v215, v165, v181
    v_xor_b32 v227, 4608, v224
    s_add_u32 s33, s32, 2359296
    buffer_store_dwordx4 v[212:215], v227, s[76:79], s33 offen sc1
    v_cvt_pk_bf16_f32 v216, v70, v86
    v_cvt_pk_bf16_f32 v217, v102, v118
    v_cvt_pk_bf16_f32 v218, v134, v150
    v_cvt_pk_bf16_f32 v219, v166, v182
    v_xor_b32 v226, 5120, v224
    s_add_u32 s33, s32, 2621440
    buffer_store_dwordx4 v[216:219], v226, s[76:79], s33 offen sc1
    v_cvt_pk_bf16_f32 v220, v71, v87
    v_cvt_pk_bf16_f32 v221, v103, v119
    v_cvt_pk_bf16_f32 v222, v135, v151
    v_cvt_pk_bf16_f32 v223, v167, v183
    v_xor_b32 v227, 5632, v224
    s_add_u32 s33, s32, 2883584
    buffer_store_dwordx4 v[220:223], v227, s[76:79], s33 offen sc1
    v_cvt_pk_bf16_f32 v192, v72, v88
    v_cvt_pk_bf16_f32 v193, v104, v120
    v_cvt_pk_bf16_f32 v194, v136, v152
    v_cvt_pk_bf16_f32 v195, v168, v184
    v_xor_b32 v226, 8192, v224
    s_add_u32 s33, s32, 4194304
    buffer_store_dwordx4 v[192:195], v226, s[76:79], s33 offen sc1
    v_cvt_pk_bf16_f32 v196, v73, v89
    v_cvt_pk_bf16_f32 v197, v105, v121
    v_cvt_pk_bf16_f32 v198, v137, v153
    v_cvt_pk_bf16_f32 v199, v169, v185
    v_xor_b32 v227, 8704, v224
    s_add_u32 s33, s32, 4456448
    buffer_store_dwordx4 v[196:199], v227, s[76:79], s33 offen sc1
    v_cvt_pk_bf16_f32 v200, v74, v90
    v_cvt_pk_bf16_f32 v201, v106, v122
    v_cvt_pk_bf16_f32 v202, v138, v154
    v_cvt_pk_bf16_f32 v203, v170, v186
    v_xor_b32 v226, 9216, v224
    s_add_u32 s33, s32, 4718592
    buffer_store_dwordx4 v[200:203], v226, s[76:79], s33 offen sc1
    v_cvt_pk_bf16_f32 v204, v75, v91
    v_cvt_pk_bf16_f32 v205, v107, v123
    v_cvt_pk_bf16_f32 v206, v139, v155
    v_cvt_pk_bf16_f32 v207, v171, v187
    v_xor_b32 v227, 9728, v224
    s_add_u32 s33, s32, 4980736
    buffer_store_dwordx4 v[204:207], v227, s[76:79], s33 offen sc1
    v_cvt_pk_bf16_f32 v208, v76, v92
    v_cvt_pk_bf16_f32 v209, v108, v124
    v_cvt_pk_bf16_f32 v210, v140, v156
    v_cvt_pk_bf16_f32 v211, v172, v188
    v_xor_b32 v226, 12288, v224
    s_add_u32 s33, s32, 6291456
    buffer_store_dwordx4 v[208:211], v226, s[76:79], s33 offen sc1
    v_cvt_pk_bf16_f32 v212, v77, v93
    v_cvt_pk_bf16_f32 v213, v109, v125
    v_cvt_pk_bf16_f32 v214, v141, v157
    v_cvt_pk_bf16_f32 v215, v173, v189
    v_xor_b32 v227, 12800, v224
    s_add_u32 s33, s32, 6553600
    buffer_store_dwordx4 v[212:215], v227, s[76:79], s33 offen sc1
    v_cvt_pk_bf16_f32 v216, v78, v94
    v_cvt_pk_bf16_f32 v217, v110, v126
    v_cvt_pk_bf16_f32 v218, v142, v158
    v_cvt_pk_bf16_f32 v219, v174, v190
    v_xor_b32 v226, 13312, v224
    s_add_u32 s33, s32, 6815744
    buffer_store_dwordx4 v[216:219], v226, s[76:79], s33 offen sc1
    v_cvt_pk_bf16_f32 v220, v79, v95
    v_cvt_pk_bf16_f32 v221, v111, v127
    v_cvt_pk_bf16_f32 v222, v143, v159
    v_cvt_pk_bf16_f32 v223, v175, v191
    v_xor_b32 v227, 13824, v224
    s_add_u32 s33, s32, 7077888
    buffer_store_dwordx4 v[220:223], v227, s[76:79], s33 offen sc1
    s_add_u32 s27, s27, 32
    s_add_u32 s34, s34, 256
    s_mov_b32 s35, 148480
    s_sub_u32 s28, s28, 1
    s_cmp_lg_u32 s28, 0
    s_cbranch_scc1 fft_unit
    s_barrier
    v_mov_b32 v240, v255
    s_cmp_lt_u32 s24, 4
    s_cbranch_scc1 pb_compute
    s_branch pb_load
k_exit:
    s_endpgm
.section .rodata,"a"
.p2align 6
.amdhsa_kernel gated_mix__spectral_fnet__dense_activation_relu__prompt_kernel
  .amdhsa_next_free_vgpr 256
  .amdhsa_next_free_sgpr 102
  .amdhsa_accum_offset 256
  .amdhsa_group_segment_fixed_size 0
  .amdhsa_kernarg_size 96
  .amdhsa_user_sgpr_count 2
  .amdhsa_user_sgpr_kernarg_segment_ptr 1
  .amdhsa_system_sgpr_workgroup_id_x 1
.end_amdhsa_kernel
```
